```python
import torch

def _softmax(x, axis=-1):
    return torch.softmax(x, dim=axis)
def _gelu(x):
    return torch.nn.functional.gelu(x, approximate="tanh")
def _silu(x):
    return torch.nn.functional.silu(x)
def _sigmoid(x):
    return torch.sigmoid(x)
def _layernorm(x, axis=-1, eps=1e-5):
    m = x.mean(dim=axis, keepdim=True)
    v = x.var(dim=axis, keepdim=True, unbiased=False)
    return (x - m) / torch.sqrt(v + eps)
def _scatter_add(tgt, idx, src, axis=0):
    return tgt.clone().index_add_(axis, idx, src)
def _segment_sum(src, seg, n):
    out = torch.zeros((n,) + src.shape[1:], dtype=src.dtype)
    return out.index_add_(0, seg, src)
def _pad(x, pw):
    flat = tuple(v for pair in reversed(pw) for v in pair)
    return torch.nn.functional.pad(x, flat)

kernel_name = 'concat_heads__gqa_block_cached__gqa_block_cached__near_ridge'

def setup_inputs():

    _w = (lambda a: (lambda t: t.to(torch.bfloat16) if t.is_floating_point() else t)(torch.as_tensor(a)))
    def _A_setup():
        B, Sq, D = 16, 32, 576
        Hq, Hkv, Sk, Dh = 32, 16, 32, 128
        assert Hq % Hkv == 0, (Hq, Hkv)
        return {
            "x": _w((lambda *s: torch.randn(*s, dtype=torch.bfloat16) * 0.8)(B, Sq, D)),
            "k_cache": _w((lambda *s: torch.randn(*s, dtype=torch.bfloat16) * 0.8)(B, Hkv, Sk, Dh)),
            "v_cache": _w((lambda *s: torch.randn(*s, dtype=torch.bfloat16) * 0.05)(B, Hkv, Sk, Dh)),
            "wq": _w((lambda *s: torch.randn(*s, dtype=torch.bfloat16) * 0.8)(D, Hq * Dh) * (D ** -0.5)),
            "wo": _w((lambda *s: torch.randn(*s, dtype=torch.bfloat16) * 0.05)(Hq * Dh, D) * ((Hq * Dh) ** -0.5)),
        }
    _A_in = _A_setup()

    def _B_setup():
        B, Sq, D = 16, 32, 576
        Hq, Hkv, Sk, Dh = 32, 16, 32, 128
        assert Hq % Hkv == 0, (Hq, Hkv)
        return {
            "x": _w((lambda *s: torch.randn(*s, dtype=torch.bfloat16) * 0.8)(B, Sq, D)),
            "k_cache": _w((lambda *s: torch.randn(*s, dtype=torch.bfloat16) * 0.8)(B, Hkv, Sk, Dh)),
            "v_cache": _w((lambda *s: torch.randn(*s, dtype=torch.bfloat16) * 0.05)(B, Hkv, Sk, Dh)),
            "wq": _w((lambda *s: torch.randn(*s, dtype=torch.bfloat16) * 0.8)(D, Hq * Dh) * (D ** -0.5)),
            "wo": _w((lambda *s: torch.randn(*s, dtype=torch.bfloat16) * 0.05)(Hq * Dh, D) * ((Hq * Dh) ** -0.5)),
        }
    _B_in = _B_setup()

    return {
        "A_x": _A_in["x"],
        "A_k_cache": _A_in["k_cache"],
        "A_v_cache": _A_in["v_cache"],
        "A_wq": _A_in["wq"],
        "A_wo": _A_in["wo"],
        "B_x": _B_in["x"],
        "B_k_cache": _B_in["k_cache"],
        "B_v_cache": _B_in["v_cache"],
        "B_wq": _B_in["wq"],
        "B_wo": _B_in["wo"],
    }

def reference(A_x, A_k_cache, A_v_cache, A_wq, A_wo, B_x, B_k_cache, B_v_cache, B_wq, B_wo):
    def _A_ref(x, k_cache, v_cache, wq, wo):
        B, Sq, D = x.shape
        Hq, Dh = 32, 128
        Hkv = k_cache.shape[1]
        rep = Hq // Hkv
        q = (lambda x, *d: x.permute(*d))((x @ wq).reshape(B, Sq, Hq, Dh), 0, 2, 1, 3)
        k = (lambda x, n, axis: torch.repeat_interleave(x, n, dim=axis))(k_cache, rep, axis=1)
        v = (lambda x, n, axis: torch.repeat_interleave(x, n, dim=axis))(v_cache, rep, axis=1)
        scores = torch.einsum("bhqd,bhkd->bhqk", q, k) * (Dh ** -0.5)
        p = _softmax(scores, axis=-1)
        o = torch.einsum("bhqk,bhkd->bhqd", p, v)
        return (lambda x, *d: x.permute(*d))(o, 0, 2, 1, 3).reshape(B, Sq, Hq * Dh) @ wo

    def _B_ref(x, k_cache, v_cache, wq, wo):
        B, Sq, D = x.shape
        Hq, Dh = 32, 128
        Hkv = k_cache.shape[1]
        rep = Hq // Hkv
        q = (lambda x, *d: x.permute(*d))((x @ wq).reshape(B, Sq, Hq, Dh), 0, 2, 1, 3)
        k = (lambda x, n, axis: torch.repeat_interleave(x, n, dim=axis))(k_cache, rep, axis=1)
        v = (lambda x, n, axis: torch.repeat_interleave(x, n, dim=axis))(v_cache, rep, axis=1)
        scores = torch.einsum("bhqd,bhkd->bhqk", q, k) * (Dh ** -0.5)
        p = _softmax(scores, axis=-1)
        o = torch.einsum("bhqk,bhkd->bhqd", p, v)
        return (lambda x, *d: x.permute(*d))(o, 0, 2, 1, 3).reshape(B, Sq, Hq * Dh) @ wo

    a = _A_ref(A_x, A_k_cache, A_v_cache, A_wq, A_wo)
    b = _B_ref(B_x, B_k_cache, B_v_cache, B_wq, B_wo)
    return torch.concatenate([a, b], axis=-1)
```

```asm
; @launch grid=(256,1,1) block=(512,1,1) lds=163840
.amdgcn_target "amdgcn-amd-amdhsa--gfx950"
.text
.globl concat_heads__gqa_block_cached__gqa_block_cached__near_ridge_kernel
.p2align 8
.type concat_heads__gqa_block_cached__gqa_block_cached__near_ridge_kernel,@function
concat_heads__gqa_block_cached__gqa_block_cached__near_ridge_kernel:
    s_cmp_ge_u32 s2, 256
    s_cbranch_scc1 L_main_end
    s_load_dwordx16 s[36:51], s[0:1], 0
    s_load_dwordx4 s[52:55], s[0:1], 64
    s_load_dwordx4 s[56:59], s[0:1], 80
    s_load_dwordx2 s[60:61], s[0:1], 96
    v_lshrrev_b32 v1, 6, v0
    v_and_b32 v0, 63, v0
    v_readfirstlane_b32 s3, v1
    s_getpc_b64 s[28:29]
L_pc0:
    s_mov_b32 s30, L_code_end-L_pc0
    s_mov_b32 s31, 0x00020000
    s_nop 0
    s_cmp_lg_u32 s3, 0
    s_cbranch_scc1 L_nopf
    s_lshr_b32 s7, s2, 3
    s_and_b32 s7, s7, 7
    s_mul_i32 s7, s7, 4096
    v_lshl_add_u32 v1, v0, 7, s7
    s_mov_b64 exec, 0xffffffff
    buffer_load_dword v19, v1, s[28:31], 0 offen
    s_mov_b64 exec, -1
L_nopf:
    s_lshr_b32 s4, s2, 2
    s_and_b32 s4, s4, 1
    s_and_b32 s5, s2, 3
    s_lshl_b32 s5, s5, 2
    s_lshr_b32 s7, s2, 6
    s_add_u32 s5, s5, s7
    s_lshr_b32 s6, s2, 3
    s_and_b32 s6, s6, 7
    s_mov_b32 s62, s6
    s_mul_i32 s63, s6, 73728
    s_lshl_b32 s100, s5, 9
    s_mul_i32 s101, s5, 294912
    s_lshl_b32 s7, s6, 5
    s_add_u32 s7, s7, s5
    s_lshl_b32 s32, s7, 13
    s_cmp_ge_u32 s3, 3
    s_cbranch_scc1 L_late
    s_cmp_eq_u32 s3, 0
    s_cbranch_scc0 L_loader
    s_lshr_b32 s7, s2, 6
    s_lshl_b32 s7, s7, 4
    v_and_b32 v1, 15, v0
    v_add_u32 v1, s7, v1
    v_mul_u32_u24 v1, 1152, v1
    v_lshrrev_b32 v2, 4, v0
    v_lshl_add_u32 v4, v2, 7, v1
    s_waitcnt lgkmcnt(0)
    s_cmp_eq_u32 s4, 0
    s_cselect_b64 s[36:37], s[36:37], s[46:47]
    s_cselect_b64 s[38:39], s[38:39], s[48:49]
    s_cselect_b64 s[40:41], s[40:41], s[50:51]
    s_cselect_b64 s[42:43], s[42:43], s[52:53]
    s_cselect_b64 s[44:45], s[44:45], s[54:55]
    s_add_u32 s8, s36, s63
    s_addc_u32 s9, s37, 0
    s_mov_b32 s10, 0x12000
    s_mov_b32 s11, 0x00020000
    s_add_u32 s12, s42, s100
    s_addc_u32 s13, s43, 0
    s_mov_b32 s14, 0x47e200
    s_mov_b32 s15, 0x00020000
    s_add_u32 s16, s44, s101
    s_addc_u32 s17, s45, 0
    s_mov_b32 s18, 0x48000
    s_mov_b32 s19, 0x00020000
    s_add_u32 s20, s38, s32
    s_addc_u32 s21, s39, 0
    s_mov_b32 s22, 0x22000
    s_mov_b32 s23, 0x00020000
    s_add_u32 s24, s40, s32
    s_addc_u32 s25, s41, 0
    s_mov_b32 s26, 0x22000
    s_mov_b32 s27, 0x00020000
    buffer_load_dword v20, v4, s[8:11], 0 offen offset:0
    s_mov_b32 s48, s8
    s_mov_b32 s52, s12
    s_mov_b32 s49, s9
    s_mov_b32 s53, s13
    s_mov_b32 s50, s10
    s_mov_b32 s54, s14
    s_mov_b32 s51, s11
    s_mov_b32 s55, s15
    s_lshl_b32 s7, s6, 3
    s_add_u32 s7, s7, 512
    v_bfe_u32 v1, v0, 2, 3
    v_add_u32 v1, s7, v1
    v_lshlrev_b32 v1, 13, v1
    v_and_b32 v2, 3, v0
    v_lshl_add_u32 v1, v2, 7, v1
    v_mov_b32 v35, v1
    s_branch L_service2
L_loader:
    s_sub_u32 s95, s3, 1
    v_lshrrev_b32 v1, 5, v0
    s_lshl_b32 s7, s95, 1
    v_add_u32 v2, s7, v1
    v_lshlrev_b32 v2, 2, v2
    v_and_b32 v3, 31, v0
    v_xor_b32 v2, v2, v3
    v_lshlrev_b32 v2, 4, v2
    v_lshl_add_u32 v2, v1, 13, v2
    s_lshl_b32 s7, s95, 14
    v_add_u32 v10, s7, v2
    v_lshrrev_b32 v1, 3, v0
    s_lshl_b32 s7, s95, 3
    v_add_u32 v1, s7, v1
    v_mul_u32_u24 v1, 1152, v1
    v_lshrrev_b32 v2, 4, v0
    s_lshl_b32 s7, s95, 2
    v_add_u32 v2, s7, v2
    v_and_b32 v3, 7, v0
    v_xor_b32 v2, v2, v3
    v_lshl_add_u32 v11, v2, 4, v1
    v_lshrrev_b32 v2, 2, v0
    v_and_b32 v2, 4, v2
    v_xor_b32 v2, v2, v3
    v_lshl_add_u32 v12, v2, 4, v1
    s_lshl_b32 s91, s95, 10
    s_waitcnt lgkmcnt(0)
    s_cmp_eq_u32 s4, 0
    s_cselect_b64 s[36:37], s[36:37], s[46:47]
    s_cselect_b64 s[42:43], s[42:43], s[52:53]
    s_cselect_b64 s[44:45], s[44:45], s[54:55]
    s_add_u32 s8, s36, s63
    s_addc_u32 s9, s37, 0
    s_mov_b32 s10, 0x12000
    s_mov_b32 s11, 0x00020000
    s_add_u32 s12, s42, s100
    s_addc_u32 s13, s43, 0
    s_mov_b32 s14, 0x47e200
    s_mov_b32 s15, 0x00020000
    s_add_u32 s16, s44, s101
    s_addc_u32 s17, s45, 0
    s_mov_b32 s18, 0x48000
    s_mov_b32 s19, 0x00020000
    s_add_u32 s89, s6, 0
    s_and_b32 s89, s89, 3
    s_lshl_b32 s89, s89, 7
    s_lshl_b32 s88, s89, 12
    s_add_u32 m0, s91, 131072
    s_nop 0
    buffer_load_dwordx4 v11, s[8:11], s89 offen lds
    s_add_u32 m0, s91, 133120
    s_add_u32 s89, s89, 18432
    buffer_load_dwordx4 v11, s[8:11], s89 offen lds
    s_add_u32 m0, s91, 135168
    s_add_u32 s89, s89, 18432
    buffer_load_dwordx4 v11, s[8:11], s89 offen lds
    s_add_u32 m0, s91, 137216
    s_add_u32 s89, s89, 18432
    buffer_load_dwordx4 v11, s[8:11], s89 offen lds
    s_add_u32 m0, s91, 0
    s_nop 0
    buffer_load_dwordx4 v10, s[12:15], s88 offen lds
    s_add_u32 m0, s91, 2048
    s_add_u32 s88, s88, 32768
    buffer_load_dwordx4 v10, s[12:15], s88 offen lds
    s_add_u32 m0, s91, 4096
    s_add_u32 s88, s88, 32768
    buffer_load_dwordx4 v10, s[12:15], s88 offen lds
    s_add_u32 m0, s91, 6144
    s_add_u32 s88, s88, 32768
    buffer_load_dwordx4 v10, s[12:15], s88 offen lds
    s_add_u32 m0, s91, 8192
    s_add_u32 s88, s88, 32768
    buffer_load_dwordx4 v10, s[12:15], s88 offen lds
    s_add_u32 m0, s91, 10240
    s_add_u32 s88, s88, 32768
    buffer_load_dwordx4 v10, s[12:15], s88 offen lds
    s_add_u32 m0, s91, 12288
    s_add_u32 s88, s88, 32768
    buffer_load_dwordx4 v10, s[12:15], s88 offen lds
    s_add_u32 m0, s91, 14336
    s_add_u32 s88, s88, 32768
    buffer_load_dwordx4 v10, s[12:15], s88 offen lds
    s_add_u32 m0, s91, 16384
    s_add_u32 s88, s88, 32768
    buffer_load_dwordx4 v10, s[12:15], s88 offen lds
    s_add_u32 m0, s91, 18432
    s_add_u32 s88, s88, 32768
    buffer_load_dwordx4 v10, s[12:15], s88 offen lds
    s_add_u32 m0, s91, 20480
    s_add_u32 s88, s88, 32768
    buffer_load_dwordx4 v10, s[12:15], s88 offen lds
    s_add_u32 m0, s91, 22528
    s_add_u32 s88, s88, 32768
    buffer_load_dwordx4 v10, s[12:15], s88 offen lds
    s_add_u32 m0, s91, 24576
    s_add_u32 s88, s88, 32768
    buffer_load_dwordx4 v10, s[12:15], s88 offen lds
    s_add_u32 m0, s91, 26624
    s_add_u32 s88, s88, 32768
    buffer_load_dwordx4 v10, s[12:15], s88 offen lds
    s_add_u32 m0, s91, 28672
    s_add_u32 s88, s88, 32768
    buffer_load_dwordx4 v10, s[12:15], s88 offen lds
    s_add_u32 m0, s91, 30720
    s_add_u32 s88, s88, 32768
    buffer_load_dwordx4 v10, s[12:15], s88 offen lds
    s_add_u32 s89, s6, 1
    s_and_b32 s89, s89, 3
    s_lshl_b32 s89, s89, 7
    s_lshl_b32 s88, s89, 12
    s_add_u32 m0, s91, 139264
    s_nop 0
    buffer_load_dwordx4 v11, s[8:11], s89 offen lds
    s_add_u32 m0, s91, 141312
    s_add_u32 s89, s89, 18432
    buffer_load_dwordx4 v11, s[8:11], s89 offen lds
    s_add_u32 m0, s91, 143360
    s_add_u32 s89, s89, 18432
    buffer_load_dwordx4 v11, s[8:11], s89 offen lds
    s_add_u32 m0, s91, 145408
    s_add_u32 s89, s89, 18432
    buffer_load_dwordx4 v11, s[8:11], s89 offen lds
    s_add_u32 m0, s91, 32768
    s_nop 0
    buffer_load_dwordx4 v10, s[12:15], s88 offen lds
    s_add_u32 m0, s91, 34816
    s_add_u32 s88, s88, 32768
    buffer_load_dwordx4 v10, s[12:15], s88 offen lds
    s_add_u32 m0, s91, 36864
    s_add_u32 s88, s88, 32768
    buffer_load_dwordx4 v10, s[12:15], s88 offen lds
    s_add_u32 m0, s91, 38912
    s_add_u32 s88, s88, 32768
    buffer_load_dwordx4 v10, s[12:15], s88 offen lds
    s_add_u32 m0, s91, 40960
    s_add_u32 s88, s88, 32768
    buffer_load_dwordx4 v10, s[12:15], s88 offen lds
    s_add_u32 m0, s91, 43008
    s_add_u32 s88, s88, 32768
    buffer_load_dwordx4 v10, s[12:15], s88 offen lds
    s_add_u32 m0, s91, 45056
    s_add_u32 s88, s88, 32768
    buffer_load_dwordx4 v10, s[12:15], s88 offen lds
    s_add_u32 m0, s91, 47104
    s_add_u32 s88, s88, 32768
    buffer_load_dwordx4 v10, s[12:15], s88 offen lds
    s_add_u32 m0, s91, 49152
    s_add_u32 s88, s88, 32768
    buffer_load_dwordx4 v10, s[12:15], s88 offen lds
    s_add_u32 m0, s91, 51200
    s_add_u32 s88, s88, 32768
    buffer_load_dwordx4 v10, s[12:15], s88 offen lds
    s_add_u32 m0, s91, 53248
    s_add_u32 s88, s88, 32768
    buffer_load_dwordx4 v10, s[12:15], s88 offen lds
    s_add_u32 m0, s91, 55296
    s_add_u32 s88, s88, 32768
    buffer_load_dwordx4 v10, s[12:15], s88 offen lds
    s_add_u32 m0, s91, 57344
    s_add_u32 s88, s88, 32768
    buffer_load_dwordx4 v10, s[12:15], s88 offen lds
    s_add_u32 m0, s91, 59392
    s_add_u32 s88, s88, 32768
    buffer_load_dwordx4 v10, s[12:15], s88 offen lds
    s_add_u32 m0, s91, 61440
    s_add_u32 s88, s88, 32768
    buffer_load_dwordx4 v10, s[12:15], s88 offen lds
    s_add_u32 m0, s91, 63488
    s_add_u32 s88, s88, 32768
    buffer_load_dwordx4 v10, s[12:15], s88 offen lds
    s_add_u32 s89, s6, 0
    s_and_b32 s89, s89, 3
    s_lshl_b32 s89, s89, 7
    s_add_u32 s89, s89, 512
    s_lshl_b32 s88, s89, 12
    s_add_u32 m0, s91, 147456
    s_nop 0
    buffer_load_dwordx4 v11, s[8:11], s89 offen lds
    s_add_u32 m0, s91, 149504
    s_add_u32 s89, s89, 18432
    buffer_load_dwordx4 v11, s[8:11], s89 offen lds
    s_add_u32 m0, s91, 151552
    s_add_u32 s89, s89, 18432
    buffer_load_dwordx4 v11, s[8:11], s89 offen lds
    s_add_u32 m0, s91, 153600
    s_add_u32 s89, s89, 18432
    buffer_load_dwordx4 v11, s[8:11], s89 offen lds
    s_add_u32 m0, s91, 65536
    s_nop 0
    buffer_load_dwordx4 v10, s[12:15], s88 offen lds
    s_add_u32 m0, s91, 67584
    s_add_u32 s88, s88, 32768
    buffer_load_dwordx4 v10, s[12:15], s88 offen lds
    s_add_u32 m0, s91, 69632
    s_add_u32 s88, s88, 32768
    buffer_load_dwordx4 v10, s[12:15], s88 offen lds
    s_add_u32 m0, s91, 71680
    s_add_u32 s88, s88, 32768
    buffer_load_dwordx4 v10, s[12:15], s88 offen lds
    s_add_u32 m0, s91, 73728
    s_add_u32 s88, s88, 32768
    buffer_load_dwordx4 v10, s[12:15], s88 offen lds
    s_add_u32 m0, s91, 75776
    s_add_u32 s88, s88, 32768
    buffer_load_dwordx4 v10, s[12:15], s88 offen lds
    s_add_u32 m0, s91, 77824
    s_add_u32 s88, s88, 32768
    buffer_load_dwordx4 v10, s[12:15], s88 offen lds
    s_add_u32 m0, s91, 79872
    s_add_u32 s88, s88, 32768
    buffer_load_dwordx4 v10, s[12:15], s88 offen lds
    s_add_u32 m0, s91, 81920
    s_add_u32 s88, s88, 32768
    buffer_load_dwordx4 v10, s[12:15], s88 offen lds
    s_add_u32 m0, s91, 83968
    s_add_u32 s88, s88, 32768
    buffer_load_dwordx4 v10, s[12:15], s88 offen lds
    s_add_u32 m0, s91, 86016
    s_add_u32 s88, s88, 32768
    buffer_load_dwordx4 v10, s[12:15], s88 offen lds
    s_add_u32 m0, s91, 88064
    s_add_u32 s88, s88, 32768
    buffer_load_dwordx4 v10, s[12:15], s88 offen lds
    s_add_u32 m0, s91, 90112
    s_add_u32 s88, s88, 32768
    buffer_load_dwordx4 v10, s[12:15], s88 offen lds
    s_add_u32 m0, s91, 92160
    s_add_u32 s88, s88, 32768
    buffer_load_dwordx4 v10, s[12:15], s88 offen lds
    s_add_u32 m0, s91, 94208
    s_add_u32 s88, s88, 32768
    buffer_load_dwordx4 v10, s[12:15], s88 offen lds
    s_add_u32 m0, s91, 96256
    s_add_u32 s88, s88, 32768
    buffer_load_dwordx4 v10, s[12:15], s88 offen lds
    s_waitcnt vmcnt(40)
    s_barrier
    s_waitcnt vmcnt(20)
    s_barrier
    s_add_u32 s89, s6, 2
    s_and_b32 s89, s89, 3
    s_lshl_b32 s89, s89, 7
    s_lshl_b32 s88, s89, 12
    s_add_u32 m0, s91, 131072
    s_nop 0
    buffer_load_dwordx4 v11, s[8:11], s89 offen lds
    s_add_u32 m0, s91, 133120
    s_add_u32 s89, s89, 18432
    buffer_load_dwordx4 v11, s[8:11], s89 offen lds
    s_add_u32 m0, s91, 135168
    s_add_u32 s89, s89, 18432
    buffer_load_dwordx4 v11, s[8:11], s89 offen lds
    s_add_u32 m0, s91, 137216
    s_add_u32 s89, s89, 18432
    buffer_load_dwordx4 v11, s[8:11], s89 offen lds
    s_add_u32 m0, s91, 0
    s_nop 0
    buffer_load_dwordx4 v10, s[12:15], s88 offen lds
    s_add_u32 m0, s91, 2048
    s_add_u32 s88, s88, 32768
    buffer_load_dwordx4 v10, s[12:15], s88 offen lds
    s_add_u32 m0, s91, 4096
    s_add_u32 s88, s88, 32768
    buffer_load_dwordx4 v10, s[12:15], s88 offen lds
    s_add_u32 m0, s91, 6144
    s_add_u32 s88, s88, 32768
    buffer_load_dwordx4 v10, s[12:15], s88 offen lds
    s_add_u32 m0, s91, 8192
    s_add_u32 s88, s88, 32768
    buffer_load_dwordx4 v10, s[12:15], s88 offen lds
    s_add_u32 m0, s91, 10240
    s_add_u32 s88, s88, 32768
    buffer_load_dwordx4 v10, s[12:15], s88 offen lds
    s_add_u32 m0, s91, 12288
    s_add_u32 s88, s88, 32768
    buffer_load_dwordx4 v10, s[12:15], s88 offen lds
    s_add_u32 m0, s91, 14336
    s_add_u32 s88, s88, 32768
    buffer_load_dwordx4 v10, s[12:15], s88 offen lds
    s_add_u32 m0, s91, 16384
    s_add_u32 s88, s88, 32768
    buffer_load_dwordx4 v10, s[12:15], s88 offen lds
    s_add_u32 m0, s91, 18432
    s_add_u32 s88, s88, 32768
    buffer_load_dwordx4 v10, s[12:15], s88 offen lds
    s_add_u32 m0, s91, 20480
    s_add_u32 s88, s88, 32768
    buffer_load_dwordx4 v10, s[12:15], s88 offen lds
    s_add_u32 m0, s91, 22528
    s_add_u32 s88, s88, 32768
    buffer_load_dwordx4 v10, s[12:15], s88 offen lds
    s_add_u32 m0, s91, 24576
    s_add_u32 s88, s88, 32768
    buffer_load_dwordx4 v10, s[12:15], s88 offen lds
    s_add_u32 m0, s91, 26624
    s_add_u32 s88, s88, 32768
    buffer_load_dwordx4 v10, s[12:15], s88 offen lds
    s_add_u32 m0, s91, 28672
    s_add_u32 s88, s88, 32768
    buffer_load_dwordx4 v10, s[12:15], s88 offen lds
    s_add_u32 m0, s91, 30720
    s_add_u32 s88, s88, 32768
    buffer_load_dwordx4 v10, s[12:15], s88 offen lds
    s_waitcnt vmcnt(20)
    s_barrier
    s_add_u32 s89, s6, 3
    s_and_b32 s89, s89, 3
    s_lshl_b32 s89, s89, 7
    s_lshl_b32 s88, s89, 12
    s_add_u32 m0, s91, 139264
    s_nop 0
    buffer_load_dwordx4 v11, s[8:11], s89 offen lds
    s_add_u32 m0, s91, 141312
    s_add_u32 s89, s89, 18432
    buffer_load_dwordx4 v11, s[8:11], s89 offen lds
    s_add_u32 m0, s91, 143360
    s_add_u32 s89, s89, 18432
    buffer_load_dwordx4 v11, s[8:11], s89 offen lds
    s_add_u32 m0, s91, 145408
    s_add_u32 s89, s89, 18432
    buffer_load_dwordx4 v11, s[8:11], s89 offen lds
    s_add_u32 m0, s91, 32768
    s_nop 0
    buffer_load_dwordx4 v10, s[12:15], s88 offen lds
    s_add_u32 m0, s91, 34816
    s_add_u32 s88, s88, 32768
    buffer_load_dwordx4 v10, s[12:15], s88 offen lds
    s_add_u32 m0, s91, 36864
    s_add_u32 s88, s88, 32768
    buffer_load_dwordx4 v10, s[12:15], s88 offen lds
    s_add_u32 m0, s91, 38912
    s_add_u32 s88, s88, 32768
    buffer_load_dwordx4 v10, s[12:15], s88 offen lds
    s_add_u32 m0, s91, 40960
    s_add_u32 s88, s88, 32768
    buffer_load_dwordx4 v10, s[12:15], s88 offen lds
    s_add_u32 m0, s91, 43008
    s_add_u32 s88, s88, 32768
    buffer_load_dwordx4 v10, s[12:15], s88 offen lds
    s_add_u32 m0, s91, 45056
    s_add_u32 s88, s88, 32768
    buffer_load_dwordx4 v10, s[12:15], s88 offen lds
    s_add_u32 m0, s91, 47104
    s_add_u32 s88, s88, 32768
    buffer_load_dwordx4 v10, s[12:15], s88 offen lds
    s_add_u32 m0, s91, 49152
    s_add_u32 s88, s88, 32768
    buffer_load_dwordx4 v10, s[12:15], s88 offen lds
    s_add_u32 m0, s91, 51200
    s_add_u32 s88, s88, 32768
    buffer_load_dwordx4 v10, s[12:15], s88 offen lds
    s_add_u32 m0, s91, 53248
    s_add_u32 s88, s88, 32768
    buffer_load_dwordx4 v10, s[12:15], s88 offen lds
    s_add_u32 m0, s91, 55296
    s_add_u32 s88, s88, 32768
    buffer_load_dwordx4 v10, s[12:15], s88 offen lds
    s_add_u32 m0, s91, 57344
    s_add_u32 s88, s88, 32768
    buffer_load_dwordx4 v10, s[12:15], s88 offen lds
    s_add_u32 m0, s91, 59392
    s_add_u32 s88, s88, 32768
    buffer_load_dwordx4 v10, s[12:15], s88 offen lds
    s_add_u32 m0, s91, 61440
    s_add_u32 s88, s88, 32768
    buffer_load_dwordx4 v10, s[12:15], s88 offen lds
    s_add_u32 m0, s91, 63488
    s_add_u32 s88, s88, 32768
    buffer_load_dwordx4 v10, s[12:15], s88 offen lds
    s_waitcnt vmcnt(20)
    s_barrier
    s_add_u32 s89, s6, 1
    s_and_b32 s89, s89, 3
    s_lshl_b32 s89, s89, 7
    s_add_u32 s89, s89, 512
    s_lshl_b32 s88, s89, 12
    s_add_u32 m0, s91, 147456
    s_nop 0
    buffer_load_dwordx4 v11, s[8:11], s89 offen lds
    s_add_u32 m0, s91, 149504
    s_add_u32 s89, s89, 18432
    buffer_load_dwordx4 v11, s[8:11], s89 offen lds
    s_add_u32 m0, s91, 151552
    s_add_u32 s89, s89, 18432
    buffer_load_dwordx4 v11, s[8:11], s89 offen lds
    s_add_u32 m0, s91, 153600
    s_add_u32 s89, s89, 18432
    buffer_load_dwordx4 v11, s[8:11], s89 offen lds
    s_add_u32 m0, s91, 65536
    s_nop 0
    buffer_load_dwordx4 v10, s[12:15], s88 offen lds
    s_add_u32 m0, s91, 67584
    s_add_u32 s88, s88, 32768
    buffer_load_dwordx4 v10, s[12:15], s88 offen lds
    s_add_u32 m0, s91, 69632
    s_add_u32 s88, s88, 32768
    buffer_load_dwordx4 v10, s[12:15], s88 offen lds
    s_add_u32 m0, s91, 71680
    s_add_u32 s88, s88, 32768
    buffer_load_dwordx4 v10, s[12:15], s88 offen lds
    s_add_u32 m0, s91, 73728
    s_add_u32 s88, s88, 32768
    buffer_load_dwordx4 v10, s[12:15], s88 offen lds
    s_add_u32 m0, s91, 75776
    s_add_u32 s88, s88, 32768
    buffer_load_dwordx4 v10, s[12:15], s88 offen lds
    s_add_u32 m0, s91, 77824
    s_add_u32 s88, s88, 32768
    buffer_load_dwordx4 v10, s[12:15], s88 offen lds
    s_add_u32 m0, s91, 79872
    s_add_u32 s88, s88, 32768
    buffer_load_dwordx4 v10, s[12:15], s88 offen lds
    s_add_u32 m0, s91, 81920
    s_add_u32 s88, s88, 32768
    buffer_load_dwordx4 v10, s[12:15], s88 offen lds
    s_add_u32 m0, s91, 83968
    s_add_u32 s88, s88, 32768
    buffer_load_dwordx4 v10, s[12:15], s88 offen lds
    s_add_u32 m0, s91, 86016
    s_add_u32 s88, s88, 32768
    buffer_load_dwordx4 v10, s[12:15], s88 offen lds
    s_add_u32 m0, s91, 88064
    s_add_u32 s88, s88, 32768
    buffer_load_dwordx4 v10, s[12:15], s88 offen lds
    s_add_u32 m0, s91, 90112
    s_add_u32 s88, s88, 32768
    buffer_load_dwordx4 v10, s[12:15], s88 offen lds
    s_add_u32 m0, s91, 92160
    s_add_u32 s88, s88, 32768
    buffer_load_dwordx4 v10, s[12:15], s88 offen lds
    s_add_u32 m0, s91, 94208
    s_add_u32 s88, s88, 32768
    buffer_load_dwordx4 v10, s[12:15], s88 offen lds
    s_add_u32 m0, s91, 96256
    s_add_u32 s88, s88, 32768
    buffer_load_dwordx4 v10, s[12:15], s88 offen lds
    s_waitcnt vmcnt(20)
    s_barrier
    s_add_u32 s89, s6, 2
    s_and_b32 s89, s89, 3
    s_lshl_b32 s89, s89, 7
    s_add_u32 s89, s89, 512
    s_lshl_b32 s88, s89, 12
    s_add_u32 m0, s91, 131072
    s_nop 0
    buffer_load_dwordx4 v11, s[8:11], s89 offen lds
    s_add_u32 m0, s91, 133120
    s_add_u32 s89, s89, 18432
    buffer_load_dwordx4 v11, s[8:11], s89 offen lds
    s_add_u32 m0, s91, 135168
    s_add_u32 s89, s89, 18432
    buffer_load_dwordx4 v11, s[8:11], s89 offen lds
    s_add_u32 m0, s91, 137216
    s_add_u32 s89, s89, 18432
    buffer_load_dwordx4 v11, s[8:11], s89 offen lds
    s_add_u32 m0, s91, 0
    s_nop 0
    buffer_load_dwordx4 v10, s[12:15], s88 offen lds
    s_add_u32 m0, s91, 2048
    s_add_u32 s88, s88, 32768
    buffer_load_dwordx4 v10, s[12:15], s88 offen lds
    s_add_u32 m0, s91, 4096
    s_add_u32 s88, s88, 32768
    buffer_load_dwordx4 v10, s[12:15], s88 offen lds
    s_add_u32 m0, s91, 6144
    s_add_u32 s88, s88, 32768
    buffer_load_dwordx4 v10, s[12:15], s88 offen lds
    s_add_u32 m0, s91, 8192
    s_add_u32 s88, s88, 32768
    buffer_load_dwordx4 v10, s[12:15], s88 offen lds
    s_add_u32 m0, s91, 10240
    s_add_u32 s88, s88, 32768
    buffer_load_dwordx4 v10, s[12:15], s88 offen lds
    s_add_u32 m0, s91, 12288
    s_add_u32 s88, s88, 32768
    buffer_load_dwordx4 v10, s[12:15], s88 offen lds
    s_add_u32 m0, s91, 14336
    s_add_u32 s88, s88, 32768
    buffer_load_dwordx4 v10, s[12:15], s88 offen lds
    s_add_u32 m0, s91, 16384
    s_add_u32 s88, s88, 32768
    buffer_load_dwordx4 v10, s[12:15], s88 offen lds
    s_add_u32 m0, s91, 18432
    s_add_u32 s88, s88, 32768
    buffer_load_dwordx4 v10, s[12:15], s88 offen lds
    s_add_u32 m0, s91, 20480
    s_add_u32 s88, s88, 32768
    buffer_load_dwordx4 v10, s[12:15], s88 offen lds
    s_add_u32 m0, s91, 22528
    s_add_u32 s88, s88, 32768
    buffer_load_dwordx4 v10, s[12:15], s88 offen lds
    s_add_u32 m0, s91, 24576
    s_add_u32 s88, s88, 32768
    buffer_load_dwordx4 v10, s[12:15], s88 offen lds
    s_add_u32 m0, s91, 26624
    s_add_u32 s88, s88, 32768
    buffer_load_dwordx4 v10, s[12:15], s88 offen lds
    s_add_u32 m0, s91, 28672
    s_add_u32 s88, s88, 32768
    buffer_load_dwordx4 v10, s[12:15], s88 offen lds
    s_add_u32 m0, s91, 30720
    s_add_u32 s88, s88, 32768
    buffer_load_dwordx4 v10, s[12:15], s88 offen lds
    s_waitcnt vmcnt(20)
    s_barrier
    s_add_u32 s89, s6, 3
    s_and_b32 s89, s89, 3
    s_lshl_b32 s89, s89, 7
    s_add_u32 s89, s89, 512
    s_lshl_b32 s88, s89, 12
    s_add_u32 m0, s91, 139264
    s_nop 0
    buffer_load_dwordx4 v11, s[8:11], s89 offen lds
    s_add_u32 m0, s91, 141312
    s_add_u32 s89, s89, 18432
    buffer_load_dwordx4 v11, s[8:11], s89 offen lds
    s_add_u32 m0, s91, 143360
    s_add_u32 s89, s89, 18432
    buffer_load_dwordx4 v11, s[8:11], s89 offen lds
    s_add_u32 m0, s91, 145408
    s_add_u32 s89, s89, 18432
    buffer_load_dwordx4 v11, s[8:11], s89 offen lds
    s_add_u32 m0, s91, 32768
    s_nop 0
    buffer_load_dwordx4 v10, s[12:15], s88 offen lds
    s_add_u32 m0, s91, 34816
    s_add_u32 s88, s88, 32768
    buffer_load_dwordx4 v10, s[12:15], s88 offen lds
    s_add_u32 m0, s91, 36864
    s_add_u32 s88, s88, 32768
    buffer_load_dwordx4 v10, s[12:15], s88 offen lds
    s_add_u32 m0, s91, 38912
    s_add_u32 s88, s88, 32768
    buffer_load_dwordx4 v10, s[12:15], s88 offen lds
    s_add_u32 m0, s91, 40960
    s_add_u32 s88, s88, 32768
    buffer_load_dwordx4 v10, s[12:15], s88 offen lds
    s_add_u32 m0, s91, 43008
    s_add_u32 s88, s88, 32768
    buffer_load_dwordx4 v10, s[12:15], s88 offen lds
    s_add_u32 m0, s91, 45056
    s_add_u32 s88, s88, 32768
    buffer_load_dwordx4 v10, s[12:15], s88 offen lds
    s_add_u32 m0, s91, 47104
    s_add_u32 s88, s88, 32768
    buffer_load_dwordx4 v10, s[12:15], s88 offen lds
    s_add_u32 m0, s91, 49152
    s_add_u32 s88, s88, 32768
    buffer_load_dwordx4 v10, s[12:15], s88 offen lds
    s_add_u32 m0, s91, 51200
    s_add_u32 s88, s88, 32768
    buffer_load_dwordx4 v10, s[12:15], s88 offen lds
    s_add_u32 m0, s91, 53248
    s_add_u32 s88, s88, 32768
    buffer_load_dwordx4 v10, s[12:15], s88 offen lds
    s_add_u32 m0, s91, 55296
    s_add_u32 s88, s88, 32768
    buffer_load_dwordx4 v10, s[12:15], s88 offen lds
    s_add_u32 m0, s91, 57344
    s_add_u32 s88, s88, 32768
    buffer_load_dwordx4 v10, s[12:15], s88 offen lds
    s_add_u32 m0, s91, 59392
    s_add_u32 s88, s88, 32768
    buffer_load_dwordx4 v10, s[12:15], s88 offen lds
    s_add_u32 m0, s91, 61440
    s_add_u32 s88, s88, 32768
    buffer_load_dwordx4 v10, s[12:15], s88 offen lds
    s_add_u32 m0, s91, 63488
    s_add_u32 s88, s88, 32768
    buffer_load_dwordx4 v10, s[12:15], s88 offen lds
    s_waitcnt vmcnt(20)
    s_barrier
    s_mov_b32 s89, 1024
    s_lshl_b32 s88, s89, 12
    s_add_u32 m0, s91, 147456
    s_nop 0
    buffer_load_dwordx4 v11, s[8:11], s89 offen lds
    s_add_u32 m0, s91, 149504
    s_add_u32 s89, s89, 18432
    buffer_load_dwordx4 v11, s[8:11], s89 offen lds
    s_add_u32 m0, s91, 151552
    s_add_u32 s89, s89, 18432
    buffer_load_dwordx4 v11, s[8:11], s89 offen lds
    s_add_u32 m0, s91, 153600
    s_add_u32 s89, s89, 18432
    buffer_load_dwordx4 v11, s[8:11], s89 offen lds
    s_add_u32 m0, s91, 65536
    s_nop 0
    buffer_load_dwordx4 v10, s[12:15], s88 offen lds
    s_add_u32 m0, s91, 67584
    s_add_u32 s88, s88, 32768
    buffer_load_dwordx4 v10, s[12:15], s88 offen lds
    s_add_u32 m0, s91, 69632
    s_add_u32 s88, s88, 32768
    buffer_load_dwordx4 v10, s[12:15], s88 offen lds
    s_add_u32 m0, s91, 71680
    s_add_u32 s88, s88, 32768
    buffer_load_dwordx4 v10, s[12:15], s88 offen lds
    s_add_u32 m0, s91, 73728
    s_add_u32 s88, s88, 32768
    buffer_load_dwordx4 v10, s[12:15], s88 offen lds
    s_add_u32 m0, s91, 75776
    s_add_u32 s88, s88, 32768
    buffer_load_dwordx4 v10, s[12:15], s88 offen lds
    s_add_u32 m0, s91, 77824
    s_add_u32 s88, s88, 32768
    buffer_load_dwordx4 v10, s[12:15], s88 offen lds
    s_add_u32 m0, s91, 79872
    s_add_u32 s88, s88, 32768
    buffer_load_dwordx4 v10, s[12:15], s88 offen lds
    s_add_u32 m0, s91, 81920
    s_add_u32 s88, s88, 32768
    buffer_load_dwordx4 v10, s[12:15], s88 offen lds
    s_add_u32 m0, s91, 83968
    s_add_u32 s88, s88, 32768
    buffer_load_dwordx4 v10, s[12:15], s88 offen lds
    s_add_u32 m0, s91, 86016
    s_add_u32 s88, s88, 32768
    buffer_load_dwordx4 v10, s[12:15], s88 offen lds
    s_add_u32 m0, s91, 88064
    s_add_u32 s88, s88, 32768
    buffer_load_dwordx4 v10, s[12:15], s88 offen lds
    s_add_u32 m0, s91, 90112
    s_add_u32 s88, s88, 32768
    buffer_load_dwordx4 v10, s[12:15], s88 offen lds
    s_add_u32 m0, s91, 92160
    s_add_u32 s88, s88, 32768
    buffer_load_dwordx4 v10, s[12:15], s88 offen lds
    s_add_u32 m0, s91, 94208
    s_add_u32 s88, s88, 32768
    buffer_load_dwordx4 v10, s[12:15], s88 offen lds
    s_add_u32 m0, s91, 96256
    s_add_u32 s88, s88, 32768
    buffer_load_dwordx4 v10, s[12:15], s88 offen lds
    s_waitcnt vmcnt(20)
    s_barrier
    s_add_u32 s88, s62, 0
    s_cmp_ge_u32 s88, 9
    s_cselect_b32 s7, 9, 0
    s_sub_u32 s88, s88, s7
    s_mul_i32 s88, s88, 128
    s_add_u32 m0, s91, 0
    s_nop 0
    buffer_load_dwordx4 v12, s[16:19], s88 offen lds
    s_add_u32 m0, s91, 2048
    s_add_u32 s88, s88, 18432
    buffer_load_dwordx4 v12, s[16:19], s88 offen lds
    s_add_u32 m0, s91, 4096
    s_add_u32 s88, s88, 18432
    buffer_load_dwordx4 v12, s[16:19], s88 offen lds
    s_add_u32 m0, s91, 6144
    s_add_u32 s88, s88, 18432
    buffer_load_dwordx4 v12, s[16:19], s88 offen lds
    s_add_u32 m0, s91, 8192
    s_add_u32 s88, s88, 18432
    buffer_load_dwordx4 v12, s[16:19], s88 offen lds
    s_add_u32 m0, s91, 10240
    s_add_u32 s88, s88, 18432
    buffer_load_dwordx4 v12, s[16:19], s88 offen lds
    s_add_u32 m0, s91, 12288
    s_add_u32 s88, s88, 18432
    buffer_load_dwordx4 v12, s[16:19], s88 offen lds
    s_add_u32 m0, s91, 14336
    s_add_u32 s88, s88, 18432
    buffer_load_dwordx4 v12, s[16:19], s88 offen lds
    s_add_u32 m0, s91, 16384
    s_add_u32 s88, s88, 18432
    buffer_load_dwordx4 v12, s[16:19], s88 offen lds
    s_add_u32 m0, s91, 18432
    s_add_u32 s88, s88, 18432
    buffer_load_dwordx4 v12, s[16:19], s88 offen lds
    s_add_u32 m0, s91, 20480
    s_add_u32 s88, s88, 18432
    buffer_load_dwordx4 v12, s[16:19], s88 offen lds
    s_add_u32 m0, s91, 22528
    s_add_u32 s88, s88, 18432
    buffer_load_dwordx4 v12, s[16:19], s88 offen lds
    s_add_u32 m0, s91, 24576
    s_add_u32 s88, s88, 18432
    buffer_load_dwordx4 v12, s[16:19], s88 offen lds
    s_add_u32 m0, s91, 26624
    s_add_u32 s88, s88, 18432
    buffer_load_dwordx4 v12, s[16:19], s88 offen lds
    s_add_u32 m0, s91, 28672
    s_add_u32 s88, s88, 18432
    buffer_load_dwordx4 v12, s[16:19], s88 offen lds
    s_add_u32 m0, s91, 30720
    s_add_u32 s88, s88, 18432
    buffer_load_dwordx4 v12, s[16:19], s88 offen lds
    s_waitcnt vmcnt(16)
    s_barrier
    s_barrier
    s_barrier
    s_add_u32 s88, s62, 1
    s_cmp_ge_u32 s88, 9
    s_cselect_b32 s7, 9, 0
    s_sub_u32 s88, s88, s7
    s_mul_i32 s88, s88, 128
    s_add_u32 m0, s91, 32768
    s_nop 0
    buffer_load_dwordx4 v12, s[16:19], s88 offen lds
    s_add_u32 m0, s91, 34816
    s_add_u32 s88, s88, 18432
    buffer_load_dwordx4 v12, s[16:19], s88 offen lds
    s_add_u32 m0, s91, 36864
    s_add_u32 s88, s88, 18432
    buffer_load_dwordx4 v12, s[16:19], s88 offen lds
    s_add_u32 m0, s91, 38912
    s_add_u32 s88, s88, 18432
    buffer_load_dwordx4 v12, s[16:19], s88 offen lds
    s_add_u32 m0, s91, 40960
    s_add_u32 s88, s88, 18432
    buffer_load_dwordx4 v12, s[16:19], s88 offen lds
    s_add_u32 m0, s91, 43008
    s_add_u32 s88, s88, 18432
    buffer_load_dwordx4 v12, s[16:19], s88 offen lds
    s_add_u32 m0, s91, 45056
    s_add_u32 s88, s88, 18432
    buffer_load_dwordx4 v12, s[16:19], s88 offen lds
    s_add_u32 m0, s91, 47104
    s_add_u32 s88, s88, 18432
    buffer_load_dwordx4 v12, s[16:19], s88 offen lds
    s_add_u32 m0, s91, 49152
    s_add_u32 s88, s88, 18432
    buffer_load_dwordx4 v12, s[16:19], s88 offen lds
    s_add_u32 m0, s91, 51200
    s_add_u32 s88, s88, 18432
    buffer_load_dwordx4 v12, s[16:19], s88 offen lds
    s_add_u32 m0, s91, 53248
    s_add_u32 s88, s88, 18432
    buffer_load_dwordx4 v12, s[16:19], s88 offen lds
    s_add_u32 m0, s91, 55296
    s_add_u32 s88, s88, 18432
    buffer_load_dwordx4 v12, s[16:19], s88 offen lds
    s_add_u32 m0, s91, 57344
    s_add_u32 s88, s88, 18432
    buffer_load_dwordx4 v12, s[16:19], s88 offen lds
    s_add_u32 m0, s91, 59392
    s_add_u32 s88, s88, 18432
    buffer_load_dwordx4 v12, s[16:19], s88 offen lds
    s_add_u32 m0, s91, 61440
    s_add_u32 s88, s88, 18432
    buffer_load_dwordx4 v12, s[16:19], s88 offen lds
    s_add_u32 m0, s91, 63488
    s_add_u32 s88, s88, 18432
    buffer_load_dwordx4 v12, s[16:19], s88 offen lds
    s_waitcnt vmcnt(16)
    s_barrier
    s_add_u32 s88, s62, 2
    s_cmp_ge_u32 s88, 9
    s_cselect_b32 s7, 9, 0
    s_sub_u32 s88, s88, s7
    s_mul_i32 s88, s88, 128
    s_add_u32 m0, s91, 65536
    s_nop 0
    buffer_load_dwordx4 v12, s[16:19], s88 offen lds
    s_add_u32 m0, s91, 67584
    s_add_u32 s88, s88, 18432
    buffer_load_dwordx4 v12, s[16:19], s88 offen lds
    s_add_u32 m0, s91, 69632
    s_add_u32 s88, s88, 18432
    buffer_load_dwordx4 v12, s[16:19], s88 offen lds
    s_add_u32 m0, s91, 71680
    s_add_u32 s88, s88, 18432
    buffer_load_dwordx4 v12, s[16:19], s88 offen lds
    s_add_u32 m0, s91, 73728
    s_add_u32 s88, s88, 18432
    buffer_load_dwordx4 v12, s[16:19], s88 offen lds
    s_add_u32 m0, s91, 75776
    s_add_u32 s88, s88, 18432
    buffer_load_dwordx4 v12, s[16:19], s88 offen lds
    s_add_u32 m0, s91, 77824
    s_add_u32 s88, s88, 18432
    buffer_load_dwordx4 v12, s[16:19], s88 offen lds
    s_add_u32 m0, s91, 79872
    s_add_u32 s88, s88, 18432
    buffer_load_dwordx4 v12, s[16:19], s88 offen lds
    s_add_u32 m0, s91, 81920
    s_add_u32 s88, s88, 18432
    buffer_load_dwordx4 v12, s[16:19], s88 offen lds
    s_add_u32 m0, s91, 83968
    s_add_u32 s88, s88, 18432
    buffer_load_dwordx4 v12, s[16:19], s88 offen lds
    s_add_u32 m0, s91, 86016
    s_add_u32 s88, s88, 18432
    buffer_load_dwordx4 v12, s[16:19], s88 offen lds
    s_add_u32 m0, s91, 88064
    s_add_u32 s88, s88, 18432
    buffer_load_dwordx4 v12, s[16:19], s88 offen lds
    s_add_u32 m0, s91, 90112
    s_add_u32 s88, s88, 18432
    buffer_load_dwordx4 v12, s[16:19], s88 offen lds
    s_add_u32 m0, s91, 92160
    s_add_u32 s88, s88, 18432
    buffer_load_dwordx4 v12, s[16:19], s88 offen lds
    s_add_u32 m0, s91, 94208
    s_add_u32 s88, s88, 18432
    buffer_load_dwordx4 v12, s[16:19], s88 offen lds
    s_add_u32 m0, s91, 96256
    s_add_u32 s88, s88, 18432
    buffer_load_dwordx4 v12, s[16:19], s88 offen lds
    s_barrier
    s_add_u32 s88, s62, 3
    s_cmp_ge_u32 s88, 9
    s_cselect_b32 s7, 9, 0
    s_sub_u32 s88, s88, s7
    s_mul_i32 s88, s88, 128
    s_add_u32 m0, s91, 98304
    s_nop 0
    buffer_load_dwordx4 v12, s[16:19], s88 offen lds
    s_add_u32 m0, s91, 100352
    s_add_u32 s88, s88, 18432
    buffer_load_dwordx4 v12, s[16:19], s88 offen lds
    s_add_u32 m0, s91, 102400
    s_add_u32 s88, s88, 18432
    buffer_load_dwordx4 v12, s[16:19], s88 offen lds
    s_add_u32 m0, s91, 104448
    s_add_u32 s88, s88, 18432
    buffer_load_dwordx4 v12, s[16:19], s88 offen lds
    s_add_u32 m0, s91, 106496
    s_add_u32 s88, s88, 18432
    buffer_load_dwordx4 v12, s[16:19], s88 offen lds
    s_add_u32 m0, s91, 108544
    s_add_u32 s88, s88, 18432
    buffer_load_dwordx4 v12, s[16:19], s88 offen lds
    s_add_u32 m0, s91, 110592
    s_add_u32 s88, s88, 18432
    buffer_load_dwordx4 v12, s[16:19], s88 offen lds
    s_add_u32 m0, s91, 112640
    s_add_u32 s88, s88, 18432
    buffer_load_dwordx4 v12, s[16:19], s88 offen lds
    s_add_u32 m0, s91, 114688
    s_add_u32 s88, s88, 18432
    buffer_load_dwordx4 v12, s[16:19], s88 offen lds
    s_add_u32 m0, s91, 116736
    s_add_u32 s88, s88, 18432
    buffer_load_dwordx4 v12, s[16:19], s88 offen lds
    s_add_u32 m0, s91, 118784
    s_add_u32 s88, s88, 18432
    buffer_load_dwordx4 v12, s[16:19], s88 offen lds
    s_add_u32 m0, s91, 120832
    s_add_u32 s88, s88, 18432
    buffer_load_dwordx4 v12, s[16:19], s88 offen lds
    s_add_u32 m0, s91, 122880
    s_add_u32 s88, s88, 18432
    buffer_load_dwordx4 v12, s[16:19], s88 offen lds
    s_add_u32 m0, s91, 124928
    s_add_u32 s88, s88, 18432
    buffer_load_dwordx4 v12, s[16:19], s88 offen lds
    s_add_u32 m0, s91, 126976
    s_add_u32 s88, s88, 18432
    buffer_load_dwordx4 v12, s[16:19], s88 offen lds
    s_add_u32 m0, s91, 129024
    s_add_u32 s88, s88, 18432
    buffer_load_dwordx4 v12, s[16:19], s88 offen lds
    s_waitcnt vmcnt(32)
    s_barrier
    s_add_u32 s88, s62, 4
    s_cmp_ge_u32 s88, 9
    s_cselect_b32 s7, 9, 0
    s_sub_u32 s88, s88, s7
    s_mul_i32 s88, s88, 128
    s_add_u32 m0, s91, 0
    s_nop 0
    buffer_load_dwordx4 v12, s[16:19], s88 offen lds
    s_add_u32 m0, s91, 2048
    s_add_u32 s88, s88, 18432
    buffer_load_dwordx4 v12, s[16:19], s88 offen lds
    s_add_u32 m0, s91, 4096
    s_add_u32 s88, s88, 18432
    buffer_load_dwordx4 v12, s[16:19], s88 offen lds
    s_add_u32 m0, s91, 6144
    s_add_u32 s88, s88, 18432
    buffer_load_dwordx4 v12, s[16:19], s88 offen lds
    s_add_u32 m0, s91, 8192
    s_add_u32 s88, s88, 18432
    buffer_load_dwordx4 v12, s[16:19], s88 offen lds
    s_add_u32 m0, s91, 10240
    s_add_u32 s88, s88, 18432
    buffer_load_dwordx4 v12, s[16:19], s88 offen lds
    s_add_u32 m0, s91, 12288
    s_add_u32 s88, s88, 18432
    buffer_load_dwordx4 v12, s[16:19], s88 offen lds
    s_add_u32 m0, s91, 14336
    s_add_u32 s88, s88, 18432
    buffer_load_dwordx4 v12, s[16:19], s88 offen lds
    s_add_u32 m0, s91, 16384
    s_add_u32 s88, s88, 18432
    buffer_load_dwordx4 v12, s[16:19], s88 offen lds
    s_add_u32 m0, s91, 18432
    s_add_u32 s88, s88, 18432
    buffer_load_dwordx4 v12, s[16:19], s88 offen lds
    s_add_u32 m0, s91, 20480
    s_add_u32 s88, s88, 18432
    buffer_load_dwordx4 v12, s[16:19], s88 offen lds
    s_add_u32 m0, s91, 22528
    s_add_u32 s88, s88, 18432
    buffer_load_dwordx4 v12, s[16:19], s88 offen lds
    s_add_u32 m0, s91, 24576
    s_add_u32 s88, s88, 18432
    buffer_load_dwordx4 v12, s[16:19], s88 offen lds
    s_add_u32 m0, s91, 26624
    s_add_u32 s88, s88, 18432
    buffer_load_dwordx4 v12, s[16:19], s88 offen lds
    s_add_u32 m0, s91, 28672
    s_add_u32 s88, s88, 18432
    buffer_load_dwordx4 v12, s[16:19], s88 offen lds
    s_add_u32 m0, s91, 30720
    s_add_u32 s88, s88, 18432
    buffer_load_dwordx4 v12, s[16:19], s88 offen lds
    s_waitcnt vmcnt(32)
    s_barrier
    s_add_u32 s88, s62, 5
    s_cmp_ge_u32 s88, 9
    s_cselect_b32 s7, 9, 0
    s_sub_u32 s88, s88, s7
    s_mul_i32 s88, s88, 128
    s_add_u32 m0, s91, 32768
    s_nop 0
    buffer_load_dwordx4 v12, s[16:19], s88 offen lds
    s_add_u32 m0, s91, 34816
    s_add_u32 s88, s88, 18432
    buffer_load_dwordx4 v12, s[16:19], s88 offen lds
    s_add_u32 m0, s91, 36864
    s_add_u32 s88, s88, 18432
    buffer_load_dwordx4 v12, s[16:19], s88 offen lds
    s_add_u32 m0, s91, 38912
    s_add_u32 s88, s88, 18432
    buffer_load_dwordx4 v12, s[16:19], s88 offen lds
    s_add_u32 m0, s91, 40960
    s_add_u32 s88, s88, 18432
    buffer_load_dwordx4 v12, s[16:19], s88 offen lds
    s_add_u32 m0, s91, 43008
    s_add_u32 s88, s88, 18432
    buffer_load_dwordx4 v12, s[16:19], s88 offen lds
    s_add_u32 m0, s91, 45056
    s_add_u32 s88, s88, 18432
    buffer_load_dwordx4 v12, s[16:19], s88 offen lds
    s_add_u32 m0, s91, 47104
    s_add_u32 s88, s88, 18432
    buffer_load_dwordx4 v12, s[16:19], s88 offen lds
    s_add_u32 m0, s91, 49152
    s_add_u32 s88, s88, 18432
    buffer_load_dwordx4 v12, s[16:19], s88 offen lds
    s_add_u32 m0, s91, 51200
    s_add_u32 s88, s88, 18432
    buffer_load_dwordx4 v12, s[16:19], s88 offen lds
    s_add_u32 m0, s91, 53248
    s_add_u32 s88, s88, 18432
    buffer_load_dwordx4 v12, s[16:19], s88 offen lds
    s_add_u32 m0, s91, 55296
    s_add_u32 s88, s88, 18432
    buffer_load_dwordx4 v12, s[16:19], s88 offen lds
    s_add_u32 m0, s91, 57344
    s_add_u32 s88, s88, 18432
    buffer_load_dwordx4 v12, s[16:19], s88 offen lds
    s_add_u32 m0, s91, 59392
    s_add_u32 s88, s88, 18432
    buffer_load_dwordx4 v12, s[16:19], s88 offen lds
    s_add_u32 m0, s91, 61440
    s_add_u32 s88, s88, 18432
    buffer_load_dwordx4 v12, s[16:19], s88 offen lds
    s_add_u32 m0, s91, 63488
    s_add_u32 s88, s88, 18432
    buffer_load_dwordx4 v12, s[16:19], s88 offen lds
    s_waitcnt vmcnt(32)
    s_barrier
    s_add_u32 s88, s62, 6
    s_cmp_ge_u32 s88, 9
    s_cselect_b32 s7, 9, 0
    s_sub_u32 s88, s88, s7
    s_mul_i32 s88, s88, 128
    s_add_u32 m0, s91, 65536
    s_nop 0
    buffer_load_dwordx4 v12, s[16:19], s88 offen lds
    s_add_u32 m0, s91, 67584
    s_add_u32 s88, s88, 18432
    buffer_load_dwordx4 v12, s[16:19], s88 offen lds
    s_add_u32 m0, s91, 69632
    s_add_u32 s88, s88, 18432
    buffer_load_dwordx4 v12, s[16:19], s88 offen lds
    s_add_u32 m0, s91, 71680
    s_add_u32 s88, s88, 18432
    buffer_load_dwordx4 v12, s[16:19], s88 offen lds
    s_add_u32 m0, s91, 73728
    s_add_u32 s88, s88, 18432
    buffer_load_dwordx4 v12, s[16:19], s88 offen lds
    s_add_u32 m0, s91, 75776
    s_add_u32 s88, s88, 18432
    buffer_load_dwordx4 v12, s[16:19], s88 offen lds
    s_add_u32 m0, s91, 77824
    s_add_u32 s88, s88, 18432
    buffer_load_dwordx4 v12, s[16:19], s88 offen lds
    s_add_u32 m0, s91, 79872
    s_add_u32 s88, s88, 18432
    buffer_load_dwordx4 v12, s[16:19], s88 offen lds
    s_add_u32 m0, s91, 81920
    s_add_u32 s88, s88, 18432
    buffer_load_dwordx4 v12, s[16:19], s88 offen lds
    s_add_u32 m0, s91, 83968
    s_add_u32 s88, s88, 18432
    buffer_load_dwordx4 v12, s[16:19], s88 offen lds
    s_add_u32 m0, s91, 86016
    s_add_u32 s88, s88, 18432
    buffer_load_dwordx4 v12, s[16:19], s88 offen lds
    s_add_u32 m0, s91, 88064
    s_add_u32 s88, s88, 18432
    buffer_load_dwordx4 v12, s[16:19], s88 offen lds
    s_add_u32 m0, s91, 90112
    s_add_u32 s88, s88, 18432
    buffer_load_dwordx4 v12, s[16:19], s88 offen lds
    s_add_u32 m0, s91, 92160
    s_add_u32 s88, s88, 18432
    buffer_load_dwordx4 v12, s[16:19], s88 offen lds
    s_add_u32 m0, s91, 94208
    s_add_u32 s88, s88, 18432
    buffer_load_dwordx4 v12, s[16:19], s88 offen lds
    s_add_u32 m0, s91, 96256
    s_add_u32 s88, s88, 18432
    buffer_load_dwordx4 v12, s[16:19], s88 offen lds
    s_waitcnt vmcnt(32)
    s_barrier
    s_add_u32 s88, s62, 7
    s_cmp_ge_u32 s88, 9
    s_cselect_b32 s7, 9, 0
    s_sub_u32 s88, s88, s7
    s_mul_i32 s88, s88, 128
    s_add_u32 m0, s91, 98304
    s_nop 0
    buffer_load_dwordx4 v12, s[16:19], s88 offen lds
    s_add_u32 m0, s91, 100352
    s_add_u32 s88, s88, 18432
    buffer_load_dwordx4 v12, s[16:19], s88 offen lds
    s_add_u32 m0, s91, 102400
    s_add_u32 s88, s88, 18432
    buffer_load_dwordx4 v12, s[16:19], s88 offen lds
    s_add_u32 m0, s91, 104448
    s_add_u32 s88, s88, 18432
    buffer_load_dwordx4 v12, s[16:19], s88 offen lds
    s_add_u32 m0, s91, 106496
    s_add_u32 s88, s88, 18432
    buffer_load_dwordx4 v12, s[16:19], s88 offen lds
    s_add_u32 m0, s91, 108544
    s_add_u32 s88, s88, 18432
    buffer_load_dwordx4 v12, s[16:19], s88 offen lds
    s_add_u32 m0, s91, 110592
    s_add_u32 s88, s88, 18432
    buffer_load_dwordx4 v12, s[16:19], s88 offen lds
    s_add_u32 m0, s91, 112640
    s_add_u32 s88, s88, 18432
    buffer_load_dwordx4 v12, s[16:19], s88 offen lds
    s_add_u32 m0, s91, 114688
    s_add_u32 s88, s88, 18432
    buffer_load_dwordx4 v12, s[16:19], s88 offen lds
    s_add_u32 m0, s91, 116736
    s_add_u32 s88, s88, 18432
    buffer_load_dwordx4 v12, s[16:19], s88 offen lds
    s_add_u32 m0, s91, 118784
    s_add_u32 s88, s88, 18432
    buffer_load_dwordx4 v12, s[16:19], s88 offen lds
    s_add_u32 m0, s91, 120832
    s_add_u32 s88, s88, 18432
    buffer_load_dwordx4 v12, s[16:19], s88 offen lds
    s_add_u32 m0, s91, 122880
    s_add_u32 s88, s88, 18432
    buffer_load_dwordx4 v12, s[16:19], s88 offen lds
    s_add_u32 m0, s91, 124928
    s_add_u32 s88, s88, 18432
    buffer_load_dwordx4 v12, s[16:19], s88 offen lds
    s_add_u32 m0, s91, 126976
    s_add_u32 s88, s88, 18432
    buffer_load_dwordx4 v12, s[16:19], s88 offen lds
    s_add_u32 m0, s91, 129024
    s_add_u32 s88, s88, 18432
    buffer_load_dwordx4 v12, s[16:19], s88 offen lds
    s_waitcnt vmcnt(32)
    s_barrier
    s_add_u32 s88, s62, 8
    s_cmp_ge_u32 s88, 9
    s_cselect_b32 s7, 9, 0
    s_sub_u32 s88, s88, s7
    s_mul_i32 s88, s88, 128
    s_add_u32 m0, s91, 0
    s_nop 0
    buffer_load_dwordx4 v12, s[16:19], s88 offen lds
    s_add_u32 m0, s91, 2048
    s_add_u32 s88, s88, 18432
    buffer_load_dwordx4 v12, s[16:19], s88 offen lds
    s_add_u32 m0, s91, 4096
    s_add_u32 s88, s88, 18432
    buffer_load_dwordx4 v12, s[16:19], s88 offen lds
    s_add_u32 m0, s91, 6144
    s_add_u32 s88, s88, 18432
    buffer_load_dwordx4 v12, s[16:19], s88 offen lds
    s_add_u32 m0, s91, 8192
    s_add_u32 s88, s88, 18432
    buffer_load_dwordx4 v12, s[16:19], s88 offen lds
    s_add_u32 m0, s91, 10240
    s_add_u32 s88, s88, 18432
    buffer_load_dwordx4 v12, s[16:19], s88 offen lds
    s_add_u32 m0, s91, 12288
    s_add_u32 s88, s88, 18432
    buffer_load_dwordx4 v12, s[16:19], s88 offen lds
    s_add_u32 m0, s91, 14336
    s_add_u32 s88, s88, 18432
    buffer_load_dwordx4 v12, s[16:19], s88 offen lds
    s_add_u32 m0, s91, 16384
    s_add_u32 s88, s88, 18432
    buffer_load_dwordx4 v12, s[16:19], s88 offen lds
    s_add_u32 m0, s91, 18432
    s_add_u32 s88, s88, 18432
    buffer_load_dwordx4 v12, s[16:19], s88 offen lds
    s_add_u32 m0, s91, 20480
    s_add_u32 s88, s88, 18432
    buffer_load_dwordx4 v12, s[16:19], s88 offen lds
    s_add_u32 m0, s91, 22528
    s_add_u32 s88, s88, 18432
    buffer_load_dwordx4 v12, s[16:19], s88 offen lds
    s_add_u32 m0, s91, 24576
    s_add_u32 s88, s88, 18432
    buffer_load_dwordx4 v12, s[16:19], s88 offen lds
    s_add_u32 m0, s91, 26624
    s_add_u32 s88, s88, 18432
    buffer_load_dwordx4 v12, s[16:19], s88 offen lds
    s_add_u32 m0, s91, 28672
    s_add_u32 s88, s88, 18432
    buffer_load_dwordx4 v12, s[16:19], s88 offen lds
    s_add_u32 m0, s91, 30720
    s_add_u32 s88, s88, 18432
    buffer_load_dwordx4 v12, s[16:19], s88 offen lds
    s_waitcnt vmcnt(32)
    s_barrier
    s_waitcnt vmcnt(16)
    s_barrier
    s_waitcnt vmcnt(0)
    s_barrier
    s_lshl_b32 s88, s4, 3
    s_add_u32 s88, s88, s6
    s_mul_i32 s88, s88, 1179648
    s_add_u32 s24, s60, s88
    s_addc_u32 s25, s61, 0
    s_mov_b32 s26, 0x120000
    s_mov_b32 s27, 0x00020000
    s_mov_b32 s8, s56
    s_mov_b32 s9, s57
    s_mov_b32 s10, 0x120000
    s_mov_b32 s11, 0x00020000
    v_mov_b32 v4, 155648
    s_bfe_u32 s88, s5, 0x10002
    s_mul_i32 s89, s88, 36864
    s_and_b32 s90, s5, 3
    s_lshl_b32 s7, s90, 7
    s_add_u32 s89, s89, s7
    s_lshr_b32 s90, s5, 3
    s_lshl_b32 s7, s90, 11
    s_add_u32 s89, s89, s7
    v_lshrrev_b32 v5, 5, v0
    v_mul_u32_u24 v7, 73728, v5
    v_bfe_u32 v6, v0, 3, 2
    v_lshl_add_u32 v7, v6, 9, v7
    v_and_b32 v6, 7, v0
    v_lshl_add_u32 v7, v6, 4, v7
    v_add_u32 v2, s89, v7
    s_and_b32 s88, s5, 7
    s_lshl_b32 s7, s6, 3
    s_add_u32 s88, s88, s7
    s_mul_i32 s88, s88, 18432
    s_mul_i32 s7, s4, 1152
    s_add_u32 s88, s88, s7
    s_lshl_b32 s7, s90, 6
    s_add_u32 s88, s88, s7
    v_mul_u32_u24 v7, 2304, v6
    v_lshl_add_u32 v7, v5, 5, v7
    v_bfe_u32 v6, v0, 3, 1
    v_lshl_add_u32 v7, v6, 4, v7
    v_bfe_u32 v6, v0, 4, 1
    v_lshl_add_u32 v7, v6, 3, v7
    v_add_u32 v3, s88, v7
    v_lshlrev_b32 v6, 2, v6
    v_bfe_u32 v5, v0, 1, 3
    v_sub_u32 v5, v5, v6
    v_and_b32 v7, 1, v0
    v_lshlrev_b32 v7, 4, v7
    v_mov_b32 v6, 0x3f80
    v_lshlrev_b32 v6, v7, v6
    v_cmp_eq_u32 vcc, 0, v5
    s_nop 1
    v_cndmask_b32 v8, 0, v6, vcc
    v_cmp_eq_u32 vcc, 1, v5
    s_nop 1
    v_cndmask_b32 v9, 0, v6, vcc
    v_cmp_eq_u32 vcc, 2, v5
    s_nop 1
    v_cndmask_b32 v10, 0, v6, vcc
    v_cmp_eq_u32 vcc, 3, v5
    s_nop 1
    v_cndmask_b32 v11, 0, v6, vcc
    s_mov_b32 s46, s95
    s_mov_b32 s47, 1
    s_mov_b32 s48, 5
    s_branch L_tail
L_extra:
    s_waitcnt lgkmcnt(0)
    s_lshl_b32 s88, s4, 3
    s_add_u32 s88, s88, s6
    s_mul_i32 s88, s88, 1179648
    s_add_u32 s24, s60, s88
    s_addc_u32 s25, s61, 0
    s_mov_b32 s26, 0x120000
    s_mov_b32 s27, 0x00020000
    s_mov_b32 s8, s56
    s_mov_b32 s9, s57
    s_mov_b32 s10, 0x120000
    s_mov_b32 s11, 0x00020000
    v_mov_b32 v4, 155648
    s_bfe_u32 s88, s5, 0x10002
    s_mul_i32 s89, s88, 36864
    s_and_b32 s90, s5, 3
    s_lshl_b32 s7, s90, 7
    s_add_u32 s89, s89, s7
    s_lshr_b32 s90, s5, 3
    s_lshl_b32 s7, s90, 11
    s_add_u32 s89, s89, s7
    v_lshrrev_b32 v5, 5, v0
    v_mul_u32_u24 v7, 73728, v5
    v_bfe_u32 v6, v0, 3, 2
    v_lshl_add_u32 v7, v6, 9, v7
    v_and_b32 v6, 7, v0
    v_lshl_add_u32 v7, v6, 4, v7
    v_add_u32 v2, s89, v7
    s_and_b32 s88, s5, 7
    s_lshl_b32 s7, s6, 3
    s_add_u32 s88, s88, s7
    s_mul_i32 s88, s88, 18432
    s_mul_i32 s7, s4, 1152
    s_add_u32 s88, s88, s7
    s_lshl_b32 s7, s90, 6
    s_add_u32 s88, s88, s7
    v_mul_u32_u24 v7, 2304, v6
    v_lshl_add_u32 v7, v5, 5, v7
    v_bfe_u32 v6, v0, 3, 1
    v_lshl_add_u32 v7, v6, 4, v7
    v_bfe_u32 v6, v0, 4, 1
    v_lshl_add_u32 v7, v6, 3, v7
    v_add_u32 v3, s88, v7
    v_lshlrev_b32 v6, 2, v6
    v_bfe_u32 v5, v0, 1, 3
    v_sub_u32 v5, v5, v6
    v_and_b32 v7, 1, v0
    v_lshlrev_b32 v7, 4, v7
    v_mov_b32 v6, 0x3f80
    v_lshlrev_b32 v6, v7, v6
    v_cmp_eq_u32 vcc, 0, v5
    s_nop 1
    v_cndmask_b32 v8, 0, v6, vcc
    v_cmp_eq_u32 vcc, 1, v5
    s_nop 1
    v_cndmask_b32 v9, 0, v6, vcc
    v_cmp_eq_u32 vcc, 2, v5
    s_nop 1
    v_cndmask_b32 v10, 0, v6, vcc
    v_cmp_eq_u32 vcc, 3, v5
    s_nop 1
    v_cndmask_b32 v11, 0, v6, vcc
    s_mov_b32 s95, 2
    s_mov_b32 s46, s95
    s_mov_b32 s47, 1
    s_mov_b32 s48, 5
    s_barrier
    s_barrier
    s_barrier
    s_barrier
    s_barrier
    s_barrier
    s_barrier
    s_barrier
    s_barrier
    s_barrier
    s_barrier
    s_barrier
    s_barrier
    s_barrier
    s_barrier
    s_barrier
    s_barrier
    s_barrier
    s_barrier
    s_barrier
    s_barrier
    s_branch L_tail
L_service2:
    v_lshlrev_b32 v5, 7, v0
    s_lshl_b32 s88, s4, 3
    s_add_u32 s88, s88, s6
    s_mul_i32 s89, s88, 69632
    s_add_u32 s89, s89, 0x2000000
    s_add_u32 s8, s60, s89
    s_addc_u32 s9, s61, 0
    s_mov_b32 s10, 0x11000
    s_mov_b32 s11, 0x00020000
    s_mov_b32 s12, s58
    s_mov_b32 s13, s59
    s_mov_b32 s14, 0x100
    s_mov_b32 s15, 0x00020000
    s_mul_i32 s7, s5, 4352
    v_lshl_add_u32 v13, v0, 2, s7
    s_lshl_b32 s7, s5, 2
    v_mul_u32_u24 v14, 4352, v0
    v_add_u32 v14, s7, v14
    s_lshl_b32 s7, s88, 4
    v_mov_b32 v15, s7
    v_mov_b32 v16, 0
    v_mov_b32 v17, 1
    s_mov_b64 exec, 0xffffffff
    buffer_store_dword v16, v13, s[8:11], 0 offen sc1
    s_mov_b64 exec, -1
    v_lshrrev_b32 v1, 4, v0
    v_and_b32 v3, 15, v0
    v_xor_b32 v2, v1, v3
    v_lshlrev_b32 v2, 4, v2
    v_lshl_add_u32 v8, v1, 8, v2
    v_xor_b32 v9, 64, v8
    v_xor_b32 v10, 128, v8
    v_xor_b32 v11, 192, v8
    v_lshlrev_b32 v2, 2, v1
    v_xor_b32 v2, v2, v3
    v_lshlrev_b32 v2, 4, v2
    v_lshl_add_u32 v12, v1, 8, v2
    v_mul_u32_u24 v6, 1152, v0
    v_and_b32 v1, 31, v0
    s_lshl_b32 s7, s6, 5
    v_add_u32 v1, s7, v1
    v_mul_u32_u24 v1, 1152, v1
    v_add_u32 v7, 1024, v1
    s_add_u32 s93, s6, 0
    s_and_b32 s93, s93, 7
    s_mul_i32 s93, s93, 5
    s_lshr_b32 s93, s93, 3
    s_add_u32 s93, s93, 2
    s_mul_i32 s94, s6, 0
    s_lshr_b32 s94, s94, 3
    s_add_u32 s94, s94, -1
    s_mov_b32 s92, 0
L_sv:
    s_barrier
    s_cmp_lg_u32 s92, 0
    s_cbranch_scc1 L_sv1
    s_waitcnt vmcnt(0)
    s_mov_b64 exec, 1
    buffer_atomic_add v17, v15, s[12:15], 0 offen sc1
    s_mov_b64 exec, -1
L_sv1:
    s_cmp_lg_u32 s92, 0
    s_cbranch_scc1 L_sv5
    buffer_load_dword v21, v4, s[48:51], 0 offen offset:512
    buffer_load_dword v22, v4, s[48:51], 0 offen offset:1024
    buffer_load_dword v23, v35, s[52:55], 0 offen
L_sv5:
    s_cmp_lg_u32 s92, s93
    s_cbranch_scc1 L_sv2
    s_mov_b32 m0, 98304
    s_mov_b32 s7, 0
    buffer_load_dwordx4 v8, s[20:23], s7 offen offset:0 nt lds
    buffer_load_dwordx4 v9, s[20:23], s7 offen offset:1024 nt lds
    buffer_load_dwordx4 v10, s[20:23], s7 offen offset:2048 nt lds
    buffer_load_dwordx4 v11, s[20:23], s7 offen offset:3072 nt lds
    s_mov_b32 m0, 102400
    s_mov_b32 s7, 4096
    buffer_load_dwordx4 v8, s[20:23], s7 offen offset:0 nt lds
    buffer_load_dwordx4 v9, s[20:23], s7 offen offset:1024 nt lds
    buffer_load_dwordx4 v10, s[20:23], s7 offen offset:2048 nt lds
    buffer_load_dwordx4 v11, s[20:23], s7 offen offset:3072 nt lds
    s_mov_b32 m0, 106496
    s_mov_b32 s7, 131072
    buffer_load_dwordx4 v8, s[20:23], s7 offen offset:0 nt lds
    buffer_load_dwordx4 v9, s[20:23], s7 offen offset:1024 nt lds
    buffer_load_dwordx4 v10, s[20:23], s7 offen offset:2048 nt lds
    buffer_load_dwordx4 v11, s[20:23], s7 offen offset:3072 nt lds
    s_mov_b32 m0, 110592
    s_mov_b32 s7, 135168
    buffer_load_dwordx4 v8, s[20:23], s7 offen offset:0 nt lds
    buffer_load_dwordx4 v9, s[20:23], s7 offen offset:1024 nt lds
    buffer_load_dwordx4 v10, s[20:23], s7 offen offset:2048 nt lds
    buffer_load_dwordx4 v11, s[20:23], s7 offen offset:3072 nt lds
    s_mov_b32 m0, 114688
    s_mov_b32 s7, 0
    buffer_load_dwordx4 v12, s[24:27], s7 offen offset:0 nt lds
    buffer_load_dwordx4 v12, s[24:27], s7 offen offset:1024 nt lds
    buffer_load_dwordx4 v12, s[24:27], s7 offen offset:2048 nt lds
    buffer_load_dwordx4 v12, s[24:27], s7 offen offset:3072 nt lds
    s_mov_b32 m0, 118784
    s_mov_b32 s7, 4096
    buffer_load_dwordx4 v12, s[24:27], s7 offen offset:0 nt lds
    buffer_load_dwordx4 v12, s[24:27], s7 offen offset:1024 nt lds
    buffer_load_dwordx4 v12, s[24:27], s7 offen offset:2048 nt lds
    buffer_load_dwordx4 v12, s[24:27], s7 offen offset:3072 nt lds
    s_mov_b32 m0, 122880
    s_mov_b32 s7, 131072
    buffer_load_dwordx4 v12, s[24:27], s7 offen offset:0 nt lds
    buffer_load_dwordx4 v12, s[24:27], s7 offen offset:1024 nt lds
    buffer_load_dwordx4 v12, s[24:27], s7 offen offset:2048 nt lds
    buffer_load_dwordx4 v12, s[24:27], s7 offen offset:3072 nt lds
    s_mov_b32 m0, 126976
    s_mov_b32 s7, 135168
    buffer_load_dwordx4 v12, s[24:27], s7 offen offset:0 nt lds
    buffer_load_dwordx4 v12, s[24:27], s7 offen offset:1024 nt lds
    buffer_load_dwordx4 v12, s[24:27], s7 offen offset:2048 nt lds
    buffer_load_dwordx4 v12, s[24:27], s7 offen offset:3072 nt lds
L_sv2:
    s_cmp_lg_u32 s92, 7
    s_cbranch_scc1 L_sv4
    buffer_load_dword v27, v7, s[16:19], 0 offen
L_sv4:
    s_add_u32 s92, s92, 1
    s_cmp_lt_u32 s92, 9
    s_cbranch_scc1 L_sv
    s_waitcnt vmcnt(1)
    s_barrier
    s_barrier
    s_barrier
    s_barrier
    s_mov_b64 exec, 1
    s_mov_b32 s7, 0
L_sp1:
    buffer_load_dword v3, v15, s[12:15], 0 offen sc1
    s_add_u32 s7, s7, 1
    s_cmp_gt_u32 s7, 30000
    s_cbranch_scc1 L_sp1_x
    s_waitcnt vmcnt(0)
    v_cmp_gt_u32 vcc, 16, v3
    s_cbranch_vccz L_sp1_x
    s_sleep 8
    s_branch L_sp1
L_sp1_x:
    s_waitcnt vmcnt(0)
    s_mov_b64 exec, -1
    s_barrier
    s_barrier
    s_barrier
    s_barrier
    s_barrier
    v_mov_b32 v18, 155648
    v_mov_b32 v19, 0
    v_mov_b32 v20, 2
    ds_write_b32 v18, v19
    ds_write_b32 v18, v19 offset:4
    s_waitcnt lgkmcnt(0)
    s_barrier
    s_barrier
    s_mov_b64 exec, 0xffff
    buffer_store_dword v17, v14, s[8:11], 0 offen sc1
    s_mov_b64 exec, -1
    s_barrier
    s_mov_b64 exec, 0xffffffff
    s_mov_b32 s7, 0
    s_mov_b32 s92, 0
L_gp:
    s_sleep 2
    buffer_load_dword v3, v13, s[8:11], 0 offen sc1
    s_add_u32 s7, s7, 1
    s_cmp_gt_u32 s7, 30000
    s_waitcnt vmcnt(0)
    s_cbranch_scc1 L_gp_x
    v_cmp_eq_u32 vcc, 0, v3
    s_cbranch_vccz L_gp_x
    s_nop 1
    s_and_b32 s88, vcc_lo, 0xffff
    s_cbranch_scc1 L_gp
    s_cmp_lg_u32 s92, 0
    s_cbranch_scc1 L_gp
    ds_write_b32 v18, v17
    s_mov_b32 s92, 1
    s_branch L_gp
L_gp_x:
    ds_write_b32 v18, v20
    s_mov_b64 exec, -1
    s_waitcnt lgkmcnt(0)
    s_branch L_done
L_late:
    s_cmp_eq_u32 s3, 7
    s_cbranch_scc1 L_extra
    s_sub_u32 s95, s3, 3
    s_and_b32 s92, s95, 1
    s_lshr_b32 s93, s95, 1
    v_lshrrev_b32 v36, 5, v0
    v_bfe_u32 v37, v0, 2, 2
    v_and_b32 v32, 1, v0
    v_lshlrev_b32 v32, 4, v32
    v_and_b32 v33, 2, v0
    v_lshl_add_u32 v32, v33, 2, v32
    v_and_b32 v33, 16, v0
    v_lshl_add_u32 v38, v33, 1, v32
    v_lshl_add_u32 v34, v36, 3, v37
    v_lshl_add_u32 v32, v34, 9, v38
    s_lshl_b32 s7, s93, 8
    v_add_u32 v32, s7, v32
    v_xor_b32 v33, 0, v37
    v_lshl_add_u32 v8, v33, 6, v32
    v_add_u32 v12, 0x10000, v8
    v_xor_b32 v33, 1, v37
    v_lshl_add_u32 v9, v33, 6, v32
    v_add_u32 v13, 0x10000, v9
    v_xor_b32 v33, 2, v37
    v_lshl_add_u32 v10, v33, 6, v32
    v_add_u32 v14, 0x10000, v10
    v_xor_b32 v33, 3, v37
    v_lshl_add_u32 v11, v33, 6, v32
    v_add_u32 v15, 0x10000, v11
    v_lshl_add_u32 v32, v34, 8, v38
    s_lshl_b32 s7, s92, 13
    s_add_u32 s7, s7, 114688
    v_add_u32 v32, s7, v32
    v_xor_b32 v33, 0, v37
    v_lshl_add_u32 v21, v33, 6, v32
    v_xor_b32 v33, 1, v37
    v_lshl_add_u32 v22, v33, 6, v32
    v_xor_b32 v33, 2, v37
    v_lshl_add_u32 v23, v33, 6, v32
    v_xor_b32 v33, 3, v37
    v_lshl_add_u32 v24, v33, 6, v32
    v_lshl_add_u32 v32, v34, 7, v38
    v_lshrrev_b32 v33, 1, v37
    v_xor_b32 v33, s93, v33
    v_lshl_add_u32 v32, v33, 6, v32
    s_lshl_b32 s7, s93, 14
    v_add_u32 v27, s7, v32
    v_xor_b32 v28, 0x4000, v27
    v_add_u32 v29, 0x10000, v27
    v_add_u32 v30, 0x10000, v28
    v_add_u32 v6, 0x20000, v27
    v_add_u32 v7, 0x20000, v28
    v_and_b32 v32, 31, v0
    v_bfe_u32 v33, v0, 1, 3
    v_xor_b32 v33, v33, v36
    v_lshlrev_b32 v33, 4, v33
    v_lshl_add_u32 v33, v32, 7, v33
    s_lshl_b32 s7, s92, 12
    s_add_u32 s7, s7, 131072
    v_add_u32 v16, s7, v33
    v_xor_b32 v17, 32, v16
    v_xor_b32 v18, 64, v16
    v_xor_b32 v19, 96, v16
    v_and_b32 v33, 0x13, v32
    v_and_b32 v34, 4, v32
    v_lshl_add_u32 v33, v34, 1, v33
    v_and_b32 v34, 8, v32
    v_lshrrev_b32 v34, 1, v34
    v_add_u32 v33, v33, v34
    v_and_b32 v34, 15, v33
    v_xor_b32 v34, v34, v36
    v_lshlrev_b32 v34, 4, v34
    v_lshl_add_u32 v33, v33, 8, v34
    s_lshl_b32 s7, s92, 13
    s_add_u32 s7, s7, 98304
    v_add_u32 v20, s7, v33
    v_xor_b32 v40, 32, v20
    v_xor_b32 v41, 64, v20
    v_xor_b32 v42, 96, v20
    v_xor_b32 v43, 128, v20
    v_xor_b32 v44, 160, v20
    v_xor_b32 v45, 192, v20
    v_xor_b32 v46, 224, v20
    s_lshl_b32 s7, s95, 13
    s_add_u32 s7, s7, 131072
    v_lshl_add_u32 v25, v0, 4, s7
    v_xor_b32 v26, 0x4000, v25
    s_mul_i32 s7, s92, 18
    s_add_u32 s7, s7, s93
    s_lshl_b32 s7, s7, 11
    v_lshl_add_u32 v31, v0, 4, s7
    s_mov_b32 s94, 0x3e0293ee
    v_mov_b32 v2, s94
    v_mov_b32 v3, s94
    s_lshl_b32 s7, s4, 3
    s_add_u32 s7, s7, s6
    s_lshl_b32 s7, s7, 4
    s_add_u32 s7, s7, s5
    s_mul_i32 s7, s7, 73728
    s_waitcnt lgkmcnt(0)
    s_add_u32 s28, s60, s7
    s_addc_u32 s29, s61, 0
    s_mov_b32 s30, 0x12000
    s_mov_b32 s31, 0x00020000
    s_lshl_b32 s88, s4, 3
    s_add_u32 s88, s88, s6
    s_mul_i32 s89, s88, 69632
    s_add_u32 s89, s89, 0x2000000
    s_add_u32 s20, s60, s89
    s_addc_u32 s21, s61, 0
    s_mov_b32 s22, 0x11000
    s_mov_b32 s23, 0x00020000
    s_lshl_b32 s7, s5, 2
    s_add_u32 s7, s7, 64
    v_mul_u32_u24 v39, 4352, v0
    v_add_u32 v39, s7, v39
    v_mov_b32 v47, 1
    v_mov_b32 v5, 155652
    s_bfe_u32 s7, s5, 0x10002
    s_lshr_b32 s88, s5, 3
    s_lshl_b32 s88, s88, 1
    s_add_u32 s7, s7, s88
    s_and_b32 s88, s5, 3
    s_lshl_b32 s88, s88, 3
    s_lshl_b32 s52, 0xff, s88
    s_cmp_eq_u32 s7, s95
    s_cselect_b32 s52, s52, 0
    s_mov_b32 s53, s52
    s_not_b32 s50, s52
    s_mov_b32 s51, s50
    v_and_b32 v32, 7, v0
    v_lshlrev_b32 v32, 4, v32
    v_lshl_add_u32 v32, v36, 7, v32
    v_add_u32 v4, 147456, v32
    s_setprio 3
    s_waitcnt lgkmcnt(0)
    s_barrier
    ds_read_b128 v[48:51], v16 offset:0
    ds_read_b64_tr_b16 v[128:129], v8 offset:0
    ds_read_b64_tr_b16 v[130:131], v8 offset:2048
    ds_read_b64_tr_b16 v[132:133], v9 offset:0
    ds_read_b64_tr_b16 v[134:135], v9 offset:2048
    ds_read_b64_tr_b16 v[136:137], v10 offset:0
    ds_read_b64_tr_b16 v[138:139], v10 offset:2048
    ds_read_b64_tr_b16 v[140:141], v11 offset:0
    ds_read_b64_tr_b16 v[142:143], v11 offset:2048
    ds_read_b128 v[52:55], v17 offset:0
    ds_read_b64_tr_b16 v[144:145], v8 offset:8192
    ds_read_b64_tr_b16 v[146:147], v8 offset:10240
    s_waitcnt lgkmcnt(9)
    v_mfma_f32_32x32x16_bf16 v[64:79], v[128:131], v[48:51], 0
    ds_read_b64_tr_b16 v[148:149], v9 offset:8192
    ds_read_b64_tr_b16 v[150:151], v9 offset:10240
    ds_read_b64_tr_b16 v[152:153], v10 offset:8192
    s_waitcnt lgkmcnt(10)
    v_mfma_f32_32x32x16_bf16 v[80:95], v[132:135], v[48:51], 0
    ds_read_b64_tr_b16 v[154:155], v10 offset:10240
    ds_read_b64_tr_b16 v[156:157], v11 offset:8192
    s_waitcnt lgkmcnt(10)
    v_mfma_f32_32x32x16_bf16 v[96:111], v[136:139], v[48:51], 0
    ds_read_b64_tr_b16 v[158:159], v11 offset:10240
    ds_read_b128 v[56:59], v18 offset:0
    s_waitcnt lgkmcnt(10)
    v_mfma_f32_32x32x16_bf16 v[112:127], v[140:143], v[48:51], 0
    ds_read_b64_tr_b16 v[128:129], v8 offset:16384
    ds_read_b64_tr_b16 v[130:131], v8 offset:18432
    s_waitcnt lgkmcnt(9)
    v_mfma_f32_32x32x16_bf16 v[64:79], v[144:147], v[52:55], v[64:79]
    ds_read_b64_tr_b16 v[132:133], v9 offset:16384
    ds_read_b64_tr_b16 v[134:135], v9 offset:18432
    ds_read_b64_tr_b16 v[136:137], v10 offset:16384
    s_waitcnt lgkmcnt(10)
    v_mfma_f32_32x32x16_bf16 v[80:95], v[148:151], v[52:55], v[80:95]
    ds_read_b64_tr_b16 v[138:139], v10 offset:18432
    ds_read_b64_tr_b16 v[140:141], v11 offset:16384
    s_waitcnt lgkmcnt(10)
    v_mfma_f32_32x32x16_bf16 v[96:111], v[152:155], v[52:55], v[96:111]
    ds_read_b64_tr_b16 v[142:143], v11 offset:18432
    ds_read_b128 v[48:51], v19 offset:0
    s_waitcnt lgkmcnt(10)
    v_mfma_f32_32x32x16_bf16 v[112:127], v[156:159], v[52:55], v[112:127]
    ds_read_b64_tr_b16 v[144:145], v8 offset:24576
    ds_read_b64_tr_b16 v[146:147], v8 offset:26624
    s_waitcnt lgkmcnt(9)
    v_mfma_f32_32x32x16_bf16 v[64:79], v[128:131], v[56:59], v[64:79]
    ds_read_b64_tr_b16 v[148:149], v9 offset:24576
    ds_read_b64_tr_b16 v[150:151], v9 offset:26624
    ds_read_b64_tr_b16 v[152:153], v10 offset:24576
    s_waitcnt lgkmcnt(10)
    v_mfma_f32_32x32x16_bf16 v[80:95], v[132:135], v[56:59], v[80:95]
    ds_read_b64_tr_b16 v[154:155], v10 offset:26624
    ds_read_b64_tr_b16 v[156:157], v11 offset:24576
    s_waitcnt lgkmcnt(10)
    v_mfma_f32_32x32x16_bf16 v[96:111], v[136:139], v[56:59], v[96:111]
    ds_read_b64_tr_b16 v[158:159], v11 offset:26624
    s_waitcnt lgkmcnt(9)
    v_mfma_f32_32x32x16_bf16 v[112:127], v[140:143], v[56:59], v[112:127]
    s_waitcnt lgkmcnt(6)
    v_mfma_f32_32x32x16_bf16 v[64:79], v[144:147], v[48:51], v[64:79]
    s_waitcnt lgkmcnt(4)
    v_mfma_f32_32x32x16_bf16 v[80:95], v[148:151], v[48:51], v[80:95]
    s_waitcnt lgkmcnt(0)
    s_barrier
    ds_read_b128 v[52:55], v16 offset:8192
    ds_read_b64_tr_b16 v[128:129], v8 offset:32768
    ds_read_b64_tr_b16 v[130:131], v8 offset:34816
    v_mfma_f32_32x32x16_bf16 v[96:111], v[152:155], v[48:51], v[96:111]
    ds_read_b64_tr_b16 v[132:133], v9 offset:32768
    ds_read_b64_tr_b16 v[134:135], v9 offset:34816
    ds_read_b64_tr_b16 v[136:137], v10 offset:32768
    v_mfma_f32_32x32x16_bf16 v[112:127], v[156:159], v[48:51], v[112:127]
    ds_read_b64_tr_b16 v[138:139], v10 offset:34816
    ds_read_b64_tr_b16 v[140:141], v11 offset:32768
    ds_read_b64_tr_b16 v[142:143], v11 offset:34816
    s_waitcnt lgkmcnt(6)
    v_mfma_f32_32x32x16_bf16 v[64:79], v[128:131], v[52:55], v[64:79]
    ds_read_b128 v[56:59], v17 offset:8192
    ds_read_b64_tr_b16 v[144:145], v8 offset:40960
    ds_read_b64_tr_b16 v[146:147], v8 offset:43008
    s_waitcnt lgkmcnt(7)
    v_mfma_f32_32x32x16_bf16 v[80:95], v[132:135], v[52:55], v[80:95]
    ds_read_b64_tr_b16 v[148:149], v9 offset:40960
    ds_read_b64_tr_b16 v[150:151], v9 offset:43008
    ds_read_b64_tr_b16 v[152:153], v10 offset:40960
    s_waitcnt lgkmcnt(8)
    v_mfma_f32_32x32x16_bf16 v[96:111], v[136:139], v[52:55], v[96:111]
    ds_read_b64_tr_b16 v[154:155], v10 offset:43008
    ds_read_b64_tr_b16 v[156:157], v11 offset:40960
    ds_read_b64_tr_b16 v[158:159], v11 offset:43008
    s_waitcnt lgkmcnt(9)
    v_mfma_f32_32x32x16_bf16 v[112:127], v[140:143], v[52:55], v[112:127]
    ds_read_b128 v[48:51], v18 offset:8192
    ds_read_b64_tr_b16 v[128:129], v8 offset:49152
    ds_read_b64_tr_b16 v[130:131], v8 offset:51200
    s_waitcnt lgkmcnt(9)
    v_mfma_f32_32x32x16_bf16 v[64:79], v[144:147], v[56:59], v[64:79]
    ds_read_b64_tr_b16 v[132:133], v9 offset:49152
    ds_read_b64_tr_b16 v[134:135], v9 offset:51200
    ds_read_b64_tr_b16 v[136:137], v10 offset:49152
    s_waitcnt lgkmcnt(10)
    v_mfma_f32_32x32x16_bf16 v[80:95], v[148:151], v[56:59], v[80:95]
    ds_read_b64_tr_b16 v[138:139], v10 offset:51200
    ds_read_b64_tr_b16 v[140:141], v11 offset:49152
    s_waitcnt lgkmcnt(10)
    v_mfma_f32_32x32x16_bf16 v[96:111], v[152:155], v[56:59], v[96:111]
    ds_read_b64_tr_b16 v[142:143], v11 offset:51200
    ds_read_b128 v[52:55], v19 offset:8192
    s_waitcnt lgkmcnt(10)
    v_mfma_f32_32x32x16_bf16 v[112:127], v[156:159], v[56:59], v[112:127]
    ds_read_b64_tr_b16 v[144:145], v8 offset:57344
    ds_read_b64_tr_b16 v[146:147], v8 offset:59392
    s_waitcnt lgkmcnt(9)
    v_mfma_f32_32x32x16_bf16 v[64:79], v[128:131], v[48:51], v[64:79]
    ds_read_b64_tr_b16 v[148:149], v9 offset:57344
    ds_read_b64_tr_b16 v[150:151], v9 offset:59392
    ds_read_b64_tr_b16 v[152:153], v10 offset:57344
    s_waitcnt lgkmcnt(10)
    v_mfma_f32_32x32x16_bf16 v[80:95], v[132:135], v[48:51], v[80:95]
    ds_read_b64_tr_b16 v[154:155], v10 offset:59392
    ds_read_b64_tr_b16 v[156:157], v11 offset:57344
    s_waitcnt lgkmcnt(10)
    v_mfma_f32_32x32x16_bf16 v[96:111], v[136:139], v[48:51], v[96:111]
    ds_read_b64_tr_b16 v[158:159], v11 offset:59392
    s_waitcnt lgkmcnt(9)
    v_mfma_f32_32x32x16_bf16 v[112:127], v[140:143], v[48:51], v[112:127]
    s_waitcnt lgkmcnt(6)
    v_mfma_f32_32x32x16_bf16 v[64:79], v[144:147], v[52:55], v[64:79]
    s_waitcnt lgkmcnt(4)
    v_mfma_f32_32x32x16_bf16 v[80:95], v[148:151], v[52:55], v[80:95]
    s_waitcnt lgkmcnt(0)
    s_barrier
    ds_read_b128 v[56:59], v16 offset:16384
    ds_read_b64_tr_b16 v[128:129], v12 offset:0
    ds_read_b64_tr_b16 v[130:131], v12 offset:2048
    v_mfma_f32_32x32x16_bf16 v[96:111], v[152:155], v[52:55], v[96:111]
    ds_read_b64_tr_b16 v[132:133], v13 offset:0
    ds_read_b64_tr_b16 v[134:135], v13 offset:2048
    ds_read_b64_tr_b16 v[136:137], v14 offset:0
    v_mfma_f32_32x32x16_bf16 v[112:127], v[156:159], v[52:55], v[112:127]
    ds_read_b64_tr_b16 v[138:139], v14 offset:2048
    ds_read_b64_tr_b16 v[140:141], v15 offset:0
    ds_read_b64_tr_b16 v[142:143], v15 offset:2048
    s_waitcnt lgkmcnt(6)
    v_mfma_f32_32x32x16_bf16 v[64:79], v[128:131], v[56:59], v[64:79]
    ds_read_b128 v[48:51], v17 offset:16384
    ds_read_b64_tr_b16 v[144:145], v12 offset:8192
    ds_read_b64_tr_b16 v[146:147], v12 offset:10240
    s_waitcnt lgkmcnt(7)
    v_mfma_f32_32x32x16_bf16 v[80:95], v[132:135], v[56:59], v[80:95]
    ds_read_b64_tr_b16 v[148:149], v13 offset:8192
    ds_read_b64_tr_b16 v[150:151], v13 offset:10240
    ds_read_b64_tr_b16 v[152:153], v14 offset:8192
    s_waitcnt lgkmcnt(8)
    v_mfma_f32_32x32x16_bf16 v[96:111], v[136:139], v[56:59], v[96:111]
    ds_read_b64_tr_b16 v[154:155], v14 offset:10240
    ds_read_b64_tr_b16 v[156:157], v15 offset:8192
    ds_read_b64_tr_b16 v[158:159], v15 offset:10240
    s_waitcnt lgkmcnt(9)
    v_mfma_f32_32x32x16_bf16 v[112:127], v[140:143], v[56:59], v[112:127]
    ds_read_b128 v[52:55], v18 offset:16384
    ds_read_b64_tr_b16 v[128:129], v12 offset:16384
    ds_read_b64_tr_b16 v[130:131], v12 offset:18432
    s_waitcnt lgkmcnt(9)
    v_mfma_f32_32x32x16_bf16 v[64:79], v[144:147], v[48:51], v[64:79]
    ds_read_b64_tr_b16 v[132:133], v13 offset:16384
    ds_read_b64_tr_b16 v[134:135], v13 offset:18432
    ds_read_b64_tr_b16 v[136:137], v14 offset:16384
    s_waitcnt lgkmcnt(10)
    v_mfma_f32_32x32x16_bf16 v[80:95], v[148:151], v[48:51], v[80:95]
    ds_read_b64_tr_b16 v[138:139], v14 offset:18432
    ds_read_b64_tr_b16 v[140:141], v15 offset:16384
    s_waitcnt lgkmcnt(10)
    v_mfma_f32_32x32x16_bf16 v[96:111], v[152:155], v[48:51], v[96:111]
    ds_read_b64_tr_b16 v[142:143], v15 offset:18432
    ds_read_b128 v[56:59], v19 offset:16384
    s_waitcnt lgkmcnt(10)
    v_mfma_f32_32x32x16_bf16 v[112:127], v[156:159], v[48:51], v[112:127]
    ds_read_b64_tr_b16 v[144:145], v12 offset:24576
    ds_read_b64_tr_b16 v[146:147], v12 offset:26624
    s_waitcnt lgkmcnt(9)
    v_mfma_f32_32x32x16_bf16 v[64:79], v[128:131], v[52:55], v[64:79]
    ds_read_b64_tr_b16 v[148:149], v13 offset:24576
    ds_read_b64_tr_b16 v[150:151], v13 offset:26624
    ds_read_b64_tr_b16 v[152:153], v14 offset:24576
    s_waitcnt lgkmcnt(10)
    v_mfma_f32_32x32x16_bf16 v[80:95], v[132:135], v[52:55], v[80:95]
    ds_read_b64_tr_b16 v[154:155], v14 offset:26624
    ds_read_b64_tr_b16 v[156:157], v15 offset:24576
    s_waitcnt lgkmcnt(10)
    v_mfma_f32_32x32x16_bf16 v[96:111], v[136:139], v[52:55], v[96:111]
    ds_read_b64_tr_b16 v[158:159], v15 offset:26624
    s_waitcnt lgkmcnt(9)
    v_mfma_f32_32x32x16_bf16 v[112:127], v[140:143], v[52:55], v[112:127]
    s_waitcnt lgkmcnt(6)
    v_mfma_f32_32x32x16_bf16 v[64:79], v[144:147], v[56:59], v[64:79]
    s_waitcnt lgkmcnt(4)
    v_mfma_f32_32x32x16_bf16 v[80:95], v[148:151], v[56:59], v[80:95]
    s_waitcnt lgkmcnt(0)
    s_barrier
    ds_read_b128 v[48:51], v16 offset:0
    ds_read_b64_tr_b16 v[128:129], v8 offset:0
    ds_read_b64_tr_b16 v[130:131], v8 offset:2048
    v_mfma_f32_32x32x16_bf16 v[96:111], v[152:155], v[56:59], v[96:111]
    ds_read_b64_tr_b16 v[132:133], v9 offset:0
    ds_read_b64_tr_b16 v[134:135], v9 offset:2048
    ds_read_b64_tr_b16 v[136:137], v10 offset:0
    v_mfma_f32_32x32x16_bf16 v[112:127], v[156:159], v[56:59], v[112:127]
    ds_read_b64_tr_b16 v[138:139], v10 offset:2048
    ds_read_b64_tr_b16 v[140:141], v11 offset:0
    ds_read_b64_tr_b16 v[142:143], v11 offset:2048
    s_waitcnt lgkmcnt(6)
    v_mfma_f32_32x32x16_bf16 v[64:79], v[128:131], v[48:51], v[64:79]
    ds_read_b128 v[52:55], v17 offset:0
    ds_read_b64_tr_b16 v[144:145], v8 offset:8192
    ds_read_b64_tr_b16 v[146:147], v8 offset:10240
    s_waitcnt lgkmcnt(7)
    v_mfma_f32_32x32x16_bf16 v[80:95], v[132:135], v[48:51], v[80:95]
    ds_read_b64_tr_b16 v[148:149], v9 offset:8192
    ds_read_b64_tr_b16 v[150:151], v9 offset:10240
    ds_read_b64_tr_b16 v[152:153], v10 offset:8192
    s_waitcnt lgkmcnt(8)
    v_mfma_f32_32x32x16_bf16 v[96:111], v[136:139], v[48:51], v[96:111]
    ds_read_b64_tr_b16 v[154:155], v10 offset:10240
    ds_read_b64_tr_b16 v[156:157], v11 offset:8192
    ds_read_b64_tr_b16 v[158:159], v11 offset:10240
    s_waitcnt lgkmcnt(9)
    v_mfma_f32_32x32x16_bf16 v[112:127], v[140:143], v[48:51], v[112:127]
    ds_read_b128 v[56:59], v18 offset:0
    ds_read_b64_tr_b16 v[128:129], v8 offset:16384
    ds_read_b64_tr_b16 v[130:131], v8 offset:18432
    s_waitcnt lgkmcnt(9)
    v_mfma_f32_32x32x16_bf16 v[64:79], v[144:147], v[52:55], v[64:79]
    ds_read_b64_tr_b16 v[132:133], v9 offset:16384
    ds_read_b64_tr_b16 v[134:135], v9 offset:18432
    ds_read_b64_tr_b16 v[136:137], v10 offset:16384
    s_waitcnt lgkmcnt(10)
    v_mfma_f32_32x32x16_bf16 v[80:95], v[148:151], v[52:55], v[80:95]
    ds_read_b64_tr_b16 v[138:139], v10 offset:18432
    ds_read_b64_tr_b16 v[140:141], v11 offset:16384
    s_waitcnt lgkmcnt(10)
    v_mfma_f32_32x32x16_bf16 v[96:111], v[152:155], v[52:55], v[96:111]
    ds_read_b64_tr_b16 v[142:143], v11 offset:18432
    ds_read_b128 v[48:51], v19 offset:0
    s_waitcnt lgkmcnt(10)
    v_mfma_f32_32x32x16_bf16 v[112:127], v[156:159], v[52:55], v[112:127]
    ds_read_b64_tr_b16 v[144:145], v8 offset:24576
    ds_read_b64_tr_b16 v[146:147], v8 offset:26624
    s_waitcnt lgkmcnt(9)
    v_mfma_f32_32x32x16_bf16 v[64:79], v[128:131], v[56:59], v[64:79]
    ds_read_b64_tr_b16 v[148:149], v9 offset:24576
    ds_read_b64_tr_b16 v[150:151], v9 offset:26624
    ds_read_b64_tr_b16 v[152:153], v10 offset:24576
    s_waitcnt lgkmcnt(10)
    v_mfma_f32_32x32x16_bf16 v[80:95], v[132:135], v[56:59], v[80:95]
    ds_read_b64_tr_b16 v[154:155], v10 offset:26624
    ds_read_b64_tr_b16 v[156:157], v11 offset:24576
    s_waitcnt lgkmcnt(10)
    v_mfma_f32_32x32x16_bf16 v[96:111], v[136:139], v[56:59], v[96:111]
    ds_read_b64_tr_b16 v[158:159], v11 offset:26624
    s_waitcnt lgkmcnt(9)
    v_mfma_f32_32x32x16_bf16 v[112:127], v[140:143], v[56:59], v[112:127]
    s_waitcnt lgkmcnt(6)
    v_mfma_f32_32x32x16_bf16 v[64:79], v[144:147], v[48:51], v[64:79]
    s_waitcnt lgkmcnt(4)
    v_mfma_f32_32x32x16_bf16 v[80:95], v[148:151], v[48:51], v[80:95]
    s_waitcnt lgkmcnt(0)
    s_barrier
    ds_read_b128 v[52:55], v16 offset:8192
    ds_read_b64_tr_b16 v[128:129], v8 offset:32768
    ds_read_b64_tr_b16 v[130:131], v8 offset:34816
    v_mfma_f32_32x32x16_bf16 v[96:111], v[152:155], v[48:51], v[96:111]
    ds_read_b64_tr_b16 v[132:133], v9 offset:32768
    ds_read_b64_tr_b16 v[134:135], v9 offset:34816
    ds_read_b64_tr_b16 v[136:137], v10 offset:32768
    v_mfma_f32_32x32x16_bf16 v[112:127], v[156:159], v[48:51], v[112:127]
    ds_read_b64_tr_b16 v[138:139], v10 offset:34816
    ds_read_b64_tr_b16 v[140:141], v11 offset:32768
    ds_read_b64_tr_b16 v[142:143], v11 offset:34816
    s_waitcnt lgkmcnt(6)
    v_mfma_f32_32x32x16_bf16 v[64:79], v[128:131], v[52:55], v[64:79]
    ds_read_b128 v[56:59], v17 offset:8192
    ds_read_b64_tr_b16 v[144:145], v8 offset:40960
    ds_read_b64_tr_b16 v[146:147], v8 offset:43008
    s_waitcnt lgkmcnt(7)
    v_mfma_f32_32x32x16_bf16 v[80:95], v[132:135], v[52:55], v[80:95]
    ds_read_b64_tr_b16 v[148:149], v9 offset:40960
    ds_read_b64_tr_b16 v[150:151], v9 offset:43008
    ds_read_b64_tr_b16 v[152:153], v10 offset:40960
    s_waitcnt lgkmcnt(8)
    v_mfma_f32_32x32x16_bf16 v[96:111], v[136:139], v[52:55], v[96:111]
    ds_read_b64_tr_b16 v[154:155], v10 offset:43008
    ds_read_b64_tr_b16 v[156:157], v11 offset:40960
    ds_read_b64_tr_b16 v[158:159], v11 offset:43008
    s_waitcnt lgkmcnt(9)
    v_mfma_f32_32x32x16_bf16 v[112:127], v[140:143], v[52:55], v[112:127]
    ds_read_b128 v[48:51], v18 offset:8192
    ds_read_b64_tr_b16 v[128:129], v8 offset:49152
    ds_read_b64_tr_b16 v[130:131], v8 offset:51200
    s_waitcnt lgkmcnt(9)
    v_mfma_f32_32x32x16_bf16 v[64:79], v[144:147], v[56:59], v[64:79]
    ds_read_b64_tr_b16 v[132:133], v9 offset:49152
    ds_read_b64_tr_b16 v[134:135], v9 offset:51200
    ds_read_b64_tr_b16 v[136:137], v10 offset:49152
    s_waitcnt lgkmcnt(10)
    v_mfma_f32_32x32x16_bf16 v[80:95], v[148:151], v[56:59], v[80:95]
    ds_read_b64_tr_b16 v[138:139], v10 offset:51200
    ds_read_b64_tr_b16 v[140:141], v11 offset:49152
    s_waitcnt lgkmcnt(10)
    v_mfma_f32_32x32x16_bf16 v[96:111], v[152:155], v[56:59], v[96:111]
    ds_read_b64_tr_b16 v[142:143], v11 offset:51200
    ds_read_b128 v[52:55], v19 offset:8192
    s_waitcnt lgkmcnt(10)
    v_mfma_f32_32x32x16_bf16 v[112:127], v[156:159], v[56:59], v[112:127]
    ds_read_b64_tr_b16 v[144:145], v8 offset:57344
    ds_read_b64_tr_b16 v[146:147], v8 offset:59392
    s_waitcnt lgkmcnt(9)
    v_mfma_f32_32x32x16_bf16 v[64:79], v[128:131], v[48:51], v[64:79]
    ds_read_b64_tr_b16 v[148:149], v9 offset:57344
    ds_read_b64_tr_b16 v[150:151], v9 offset:59392
    ds_read_b64_tr_b16 v[152:153], v10 offset:57344
    s_waitcnt lgkmcnt(10)
    v_mfma_f32_32x32x16_bf16 v[80:95], v[132:135], v[48:51], v[80:95]
    ds_read_b64_tr_b16 v[154:155], v10 offset:59392
    ds_read_b64_tr_b16 v[156:157], v11 offset:57344
    s_waitcnt lgkmcnt(10)
    v_mfma_f32_32x32x16_bf16 v[96:111], v[136:139], v[48:51], v[96:111]
    ds_read_b64_tr_b16 v[158:159], v11 offset:59392
    s_waitcnt lgkmcnt(9)
    v_mfma_f32_32x32x16_bf16 v[112:127], v[140:143], v[48:51], v[112:127]
    s_waitcnt lgkmcnt(6)
    v_mfma_f32_32x32x16_bf16 v[64:79], v[144:147], v[52:55], v[64:79]
    s_waitcnt lgkmcnt(4)
    v_mfma_f32_32x32x16_bf16 v[80:95], v[148:151], v[52:55], v[80:95]
    s_waitcnt lgkmcnt(0)
    s_barrier
    ds_read_b128 v[56:59], v16 offset:16384
    ds_read_b64_tr_b16 v[128:129], v12 offset:0
    ds_read_b64_tr_b16 v[130:131], v12 offset:2048
    v_mfma_f32_32x32x16_bf16 v[96:111], v[152:155], v[52:55], v[96:111]
    ds_read_b64_tr_b16 v[132:133], v13 offset:0
    ds_read_b64_tr_b16 v[134:135], v13 offset:2048
    ds_read_b64_tr_b16 v[136:137], v14 offset:0
    v_mfma_f32_32x32x16_bf16 v[112:127], v[156:159], v[52:55], v[112:127]
    ds_read_b64_tr_b16 v[138:139], v14 offset:2048
    ds_read_b64_tr_b16 v[140:141], v15 offset:0
    ds_read_b64_tr_b16 v[142:143], v15 offset:2048
    s_waitcnt lgkmcnt(6)
    v_mfma_f32_32x32x16_bf16 v[64:79], v[128:131], v[56:59], v[64:79]
    ds_read_b128 v[48:51], v17 offset:16384
    ds_read_b64_tr_b16 v[144:145], v12 offset:8192
    ds_read_b64_tr_b16 v[146:147], v12 offset:10240
    s_waitcnt lgkmcnt(7)
    v_mfma_f32_32x32x16_bf16 v[80:95], v[132:135], v[56:59], v[80:95]
    ds_read_b64_tr_b16 v[148:149], v13 offset:8192
    ds_read_b64_tr_b16 v[150:151], v13 offset:10240
    ds_read_b64_tr_b16 v[152:153], v14 offset:8192
    s_waitcnt lgkmcnt(8)
    v_mfma_f32_32x32x16_bf16 v[96:111], v[136:139], v[56:59], v[96:111]
    ds_read_b64_tr_b16 v[154:155], v14 offset:10240
    ds_read_b64_tr_b16 v[156:157], v15 offset:8192
    ds_read_b64_tr_b16 v[158:159], v15 offset:10240
    s_waitcnt lgkmcnt(9)
    v_mfma_f32_32x32x16_bf16 v[112:127], v[140:143], v[56:59], v[112:127]
    ds_read_b128 v[52:55], v18 offset:16384
    ds_read_b64_tr_b16 v[128:129], v12 offset:16384
    ds_read_b64_tr_b16 v[130:131], v12 offset:18432
    s_waitcnt lgkmcnt(9)
    v_mfma_f32_32x32x16_bf16 v[64:79], v[144:147], v[48:51], v[64:79]
    ds_read_b64_tr_b16 v[132:133], v13 offset:16384
    ds_read_b64_tr_b16 v[134:135], v13 offset:18432
    ds_read_b64_tr_b16 v[136:137], v14 offset:16384
    s_waitcnt lgkmcnt(10)
    v_mfma_f32_32x32x16_bf16 v[80:95], v[148:151], v[48:51], v[80:95]
    ds_read_b64_tr_b16 v[138:139], v14 offset:18432
    ds_read_b64_tr_b16 v[140:141], v15 offset:16384
    s_waitcnt lgkmcnt(10)
    v_mfma_f32_32x32x16_bf16 v[96:111], v[152:155], v[48:51], v[96:111]
    ds_read_b64_tr_b16 v[142:143], v15 offset:18432
    ds_read_b128 v[56:59], v19 offset:16384
    s_waitcnt lgkmcnt(10)
    v_mfma_f32_32x32x16_bf16 v[112:127], v[156:159], v[48:51], v[112:127]
    ds_read_b64_tr_b16 v[144:145], v12 offset:24576
    ds_read_b64_tr_b16 v[146:147], v12 offset:26624
    s_waitcnt lgkmcnt(9)
    v_mfma_f32_32x32x16_bf16 v[64:79], v[128:131], v[52:55], v[64:79]
    ds_read_b64_tr_b16 v[148:149], v13 offset:24576
    ds_read_b64_tr_b16 v[150:151], v13 offset:26624
    ds_read_b64_tr_b16 v[152:153], v14 offset:24576
    s_waitcnt lgkmcnt(10)
    v_mfma_f32_32x32x16_bf16 v[80:95], v[132:135], v[52:55], v[80:95]
    ds_read_b64_tr_b16 v[154:155], v14 offset:26624
    ds_read_b64_tr_b16 v[156:157], v15 offset:24576
    s_waitcnt lgkmcnt(10)
    v_mfma_f32_32x32x16_bf16 v[96:111], v[136:139], v[52:55], v[96:111]
    ds_read_b64_tr_b16 v[158:159], v15 offset:26624
    s_waitcnt lgkmcnt(9)
    v_mfma_f32_32x32x16_bf16 v[112:127], v[140:143], v[52:55], v[112:127]
    s_waitcnt lgkmcnt(6)
    v_mfma_f32_32x32x16_bf16 v[64:79], v[144:147], v[56:59], v[64:79]
    s_waitcnt lgkmcnt(4)
    v_mfma_f32_32x32x16_bf16 v[80:95], v[148:151], v[56:59], v[80:95]
    s_waitcnt lgkmcnt(0)
    s_barrier
    ds_read_b128 v[48:51], v16 offset:0
    ds_read_b64_tr_b16 v[128:129], v8 offset:0
    ds_read_b64_tr_b16 v[130:131], v8 offset:2048
    v_mfma_f32_32x32x16_bf16 v[96:111], v[152:155], v[56:59], v[96:111]
    ds_read_b64_tr_b16 v[132:133], v9 offset:0
    ds_read_b64_tr_b16 v[134:135], v9 offset:2048
    ds_read_b64_tr_b16 v[136:137], v10 offset:0
    v_mfma_f32_32x32x16_bf16 v[112:127], v[156:159], v[56:59], v[112:127]
    ds_read_b64_tr_b16 v[138:139], v10 offset:2048
    ds_read_b64_tr_b16 v[140:141], v11 offset:0
    ds_read_b64_tr_b16 v[142:143], v11 offset:2048
    s_waitcnt lgkmcnt(6)
    v_mfma_f32_32x32x16_bf16 v[64:79], v[128:131], v[48:51], v[64:79]
    ds_read_b128 v[52:55], v17 offset:0
    ds_read_b64_tr_b16 v[144:145], v8 offset:8192
    ds_read_b64_tr_b16 v[146:147], v8 offset:10240
    s_waitcnt lgkmcnt(7)
    v_mfma_f32_32x32x16_bf16 v[80:95], v[132:135], v[48:51], v[80:95]
    ds_read_b64_tr_b16 v[148:149], v9 offset:8192
    ds_read_b64_tr_b16 v[150:151], v9 offset:10240
    ds_read_b64_tr_b16 v[152:153], v10 offset:8192
    s_waitcnt lgkmcnt(8)
    v_mfma_f32_32x32x16_bf16 v[96:111], v[136:139], v[48:51], v[96:111]
    ds_read_b64_tr_b16 v[154:155], v10 offset:10240
    ds_read_b64_tr_b16 v[156:157], v11 offset:8192
    ds_read_b64_tr_b16 v[158:159], v11 offset:10240
    s_waitcnt lgkmcnt(9)
    v_mfma_f32_32x32x16_bf16 v[112:127], v[140:143], v[48:51], v[112:127]
    ds_read_b128 v[56:59], v18 offset:0
    ds_read_b64_tr_b16 v[128:129], v8 offset:16384
    ds_read_b64_tr_b16 v[130:131], v8 offset:18432
    s_waitcnt lgkmcnt(9)
    v_mfma_f32_32x32x16_bf16 v[64:79], v[144:147], v[52:55], v[64:79]
    ds_read_b64_tr_b16 v[132:133], v9 offset:16384
    ds_read_b64_tr_b16 v[134:135], v9 offset:18432
    ds_read_b64_tr_b16 v[136:137], v10 offset:16384
    s_waitcnt lgkmcnt(10)
    v_mfma_f32_32x32x16_bf16 v[80:95], v[148:151], v[52:55], v[80:95]
    ds_read_b64_tr_b16 v[138:139], v10 offset:18432
    ds_read_b64_tr_b16 v[140:141], v11 offset:16384
    s_waitcnt lgkmcnt(10)
    v_mfma_f32_32x32x16_bf16 v[96:111], v[152:155], v[52:55], v[96:111]
    ds_read_b64_tr_b16 v[142:143], v11 offset:18432
    ds_read_b128 v[48:51], v19 offset:0
    s_waitcnt lgkmcnt(10)
    v_mfma_f32_32x32x16_bf16 v[112:127], v[156:159], v[52:55], v[112:127]
    ds_read_b64_tr_b16 v[144:145], v8 offset:24576
    ds_read_b64_tr_b16 v[146:147], v8 offset:26624
    s_waitcnt lgkmcnt(9)
    v_mfma_f32_32x32x16_bf16 v[64:79], v[128:131], v[56:59], v[64:79]
    ds_read_b64_tr_b16 v[148:149], v9 offset:24576
    ds_read_b64_tr_b16 v[150:151], v9 offset:26624
    ds_read_b64_tr_b16 v[152:153], v10 offset:24576
    s_waitcnt lgkmcnt(10)
    v_mfma_f32_32x32x16_bf16 v[80:95], v[132:135], v[56:59], v[80:95]
    ds_read_b64_tr_b16 v[154:155], v10 offset:26624
    ds_read_b64_tr_b16 v[156:157], v11 offset:24576
    s_waitcnt lgkmcnt(10)
    v_mfma_f32_32x32x16_bf16 v[96:111], v[136:139], v[56:59], v[96:111]
    ds_read_b64_tr_b16 v[158:159], v11 offset:26624
    s_waitcnt lgkmcnt(9)
    v_mfma_f32_32x32x16_bf16 v[112:127], v[140:143], v[56:59], v[112:127]
    s_waitcnt lgkmcnt(6)
    v_mfma_f32_32x32x16_bf16 v[64:79], v[144:147], v[48:51], v[64:79]
    s_waitcnt lgkmcnt(4)
    v_mfma_f32_32x32x16_bf16 v[80:95], v[148:151], v[48:51], v[80:95]
    s_waitcnt lgkmcnt(0)
    s_barrier
    ds_read_b128 v[52:55], v16 offset:8192
    ds_read_b64_tr_b16 v[128:129], v8 offset:32768
    ds_read_b64_tr_b16 v[130:131], v8 offset:34816
    v_mfma_f32_32x32x16_bf16 v[96:111], v[152:155], v[48:51], v[96:111]
    ds_read_b64_tr_b16 v[132:133], v9 offset:32768
    ds_read_b64_tr_b16 v[134:135], v9 offset:34816
    ds_read_b64_tr_b16 v[136:137], v10 offset:32768
    v_mfma_f32_32x32x16_bf16 v[112:127], v[156:159], v[48:51], v[112:127]
    ds_read_b64_tr_b16 v[138:139], v10 offset:34816
    ds_read_b64_tr_b16 v[140:141], v11 offset:32768
    ds_read_b64_tr_b16 v[142:143], v11 offset:34816
    s_waitcnt lgkmcnt(6)
    v_mfma_f32_32x32x16_bf16 v[64:79], v[128:131], v[52:55], v[64:79]
    ds_read_b128 v[56:59], v17 offset:8192
    ds_read_b64_tr_b16 v[144:145], v8 offset:40960
    ds_read_b64_tr_b16 v[146:147], v8 offset:43008
    s_waitcnt lgkmcnt(7)
    v_mfma_f32_32x32x16_bf16 v[80:95], v[132:135], v[52:55], v[80:95]
    ds_read_b64_tr_b16 v[148:149], v9 offset:40960
    ds_read_b64_tr_b16 v[150:151], v9 offset:43008
    ds_read_b64_tr_b16 v[152:153], v10 offset:40960
    s_waitcnt lgkmcnt(8)
    v_mfma_f32_32x32x16_bf16 v[96:111], v[136:139], v[52:55], v[96:111]
    ds_read_b64_tr_b16 v[154:155], v10 offset:43008
    ds_read_b64_tr_b16 v[156:157], v11 offset:40960
    ds_read_b64_tr_b16 v[158:159], v11 offset:43008
    s_waitcnt lgkmcnt(9)
    v_mfma_f32_32x32x16_bf16 v[112:127], v[140:143], v[52:55], v[112:127]
    ds_read_b128 v[48:51], v18 offset:8192
    ds_read_b64_tr_b16 v[128:129], v8 offset:49152
    ds_read_b64_tr_b16 v[130:131], v8 offset:51200
    s_waitcnt lgkmcnt(9)
    v_mfma_f32_32x32x16_bf16 v[64:79], v[144:147], v[56:59], v[64:79]
    ds_read_b64_tr_b16 v[132:133], v9 offset:49152
    ds_read_b64_tr_b16 v[134:135], v9 offset:51200
    ds_read_b64_tr_b16 v[136:137], v10 offset:49152
    s_waitcnt lgkmcnt(10)
    v_mfma_f32_32x32x16_bf16 v[80:95], v[148:151], v[56:59], v[80:95]
    ds_read_b64_tr_b16 v[138:139], v10 offset:51200
    ds_read_b64_tr_b16 v[140:141], v11 offset:49152
    s_waitcnt lgkmcnt(10)
    v_mfma_f32_32x32x16_bf16 v[96:111], v[152:155], v[56:59], v[96:111]
    ds_read_b64_tr_b16 v[142:143], v11 offset:51200
    ds_read_b128 v[52:55], v19 offset:8192
    s_waitcnt lgkmcnt(10)
    v_mfma_f32_32x32x16_bf16 v[112:127], v[156:159], v[56:59], v[112:127]
    ds_read_b64_tr_b16 v[144:145], v8 offset:57344
    ds_read_b64_tr_b16 v[146:147], v8 offset:59392
    s_waitcnt lgkmcnt(9)
    v_mfma_f32_32x32x16_bf16 v[64:79], v[128:131], v[48:51], v[64:79]
    ds_read_b64_tr_b16 v[148:149], v9 offset:57344
    ds_read_b64_tr_b16 v[150:151], v9 offset:59392
    ds_read_b64_tr_b16 v[152:153], v10 offset:57344
    s_waitcnt lgkmcnt(10)
    v_mfma_f32_32x32x16_bf16 v[80:95], v[132:135], v[48:51], v[80:95]
    ds_read_b64_tr_b16 v[154:155], v10 offset:59392
    ds_read_b64_tr_b16 v[156:157], v11 offset:57344
    s_waitcnt lgkmcnt(10)
    v_mfma_f32_32x32x16_bf16 v[96:111], v[136:139], v[48:51], v[96:111]
    ds_read_b64_tr_b16 v[158:159], v11 offset:59392
    s_waitcnt lgkmcnt(9)
    v_mfma_f32_32x32x16_bf16 v[112:127], v[140:143], v[48:51], v[112:127]
    s_waitcnt lgkmcnt(6)
    v_mfma_f32_32x32x16_bf16 v[64:79], v[144:147], v[52:55], v[64:79]
    s_waitcnt lgkmcnt(4)
    v_mfma_f32_32x32x16_bf16 v[80:95], v[148:151], v[52:55], v[80:95]
    s_waitcnt lgkmcnt(0)
    s_barrier
    ds_read_b128 v[56:59], v16 offset:16384
    ds_read_b64_tr_b16 v[128:129], v12 offset:0
    ds_read_b64_tr_b16 v[130:131], v12 offset:2048
    v_mfma_f32_32x32x16_bf16 v[96:111], v[152:155], v[52:55], v[96:111]
    ds_read_b64_tr_b16 v[132:133], v13 offset:0
    ds_read_b64_tr_b16 v[134:135], v13 offset:2048
    ds_read_b64_tr_b16 v[136:137], v14 offset:0
    v_mfma_f32_32x32x16_bf16 v[112:127], v[156:159], v[52:55], v[112:127]
    ds_read_b64_tr_b16 v[138:139], v14 offset:2048
    ds_read_b64_tr_b16 v[140:141], v15 offset:0
    ds_read_b64_tr_b16 v[142:143], v15 offset:2048
    s_waitcnt lgkmcnt(6)
    v_mfma_f32_32x32x16_bf16 v[64:79], v[128:131], v[56:59], v[64:79]
    ds_read_b128 v[48:51], v17 offset:16384
    ds_read_b64_tr_b16 v[144:145], v12 offset:8192
    ds_read_b64_tr_b16 v[146:147], v12 offset:10240
    s_waitcnt lgkmcnt(7)
    v_mfma_f32_32x32x16_bf16 v[80:95], v[132:135], v[56:59], v[80:95]
    ds_read_b64_tr_b16 v[148:149], v13 offset:8192
    ds_read_b64_tr_b16 v[150:151], v13 offset:10240
    ds_read_b64_tr_b16 v[152:153], v14 offset:8192
    s_waitcnt lgkmcnt(8)
    v_mfma_f32_32x32x16_bf16 v[96:111], v[136:139], v[56:59], v[96:111]
    ds_read_b64_tr_b16 v[154:155], v14 offset:10240
    ds_read_b64_tr_b16 v[156:157], v15 offset:8192
    ds_read_b64_tr_b16 v[158:159], v15 offset:10240
    s_waitcnt lgkmcnt(9)
    v_mfma_f32_32x32x16_bf16 v[112:127], v[140:143], v[56:59], v[112:127]
    ds_read_b128 v[52:55], v18 offset:16384
    ds_read_b64_tr_b16 v[128:129], v12 offset:16384
    ds_read_b64_tr_b16 v[130:131], v12 offset:18432
    s_waitcnt lgkmcnt(9)
    v_mfma_f32_32x32x16_bf16 v[64:79], v[144:147], v[48:51], v[64:79]
    ds_read_b64_tr_b16 v[132:133], v13 offset:16384
    ds_read_b64_tr_b16 v[134:135], v13 offset:18432
    ds_read_b64_tr_b16 v[136:137], v14 offset:16384
    s_waitcnt lgkmcnt(10)
    v_mfma_f32_32x32x16_bf16 v[80:95], v[148:151], v[48:51], v[80:95]
    ds_read_b64_tr_b16 v[138:139], v14 offset:18432
    ds_read_b64_tr_b16 v[140:141], v15 offset:16384
    s_waitcnt lgkmcnt(10)
    v_mfma_f32_32x32x16_bf16 v[96:111], v[152:155], v[48:51], v[96:111]
    ds_read_b64_tr_b16 v[142:143], v15 offset:18432
    ds_read_b128 v[56:59], v19 offset:16384
    s_waitcnt lgkmcnt(10)
    v_mfma_f32_32x32x16_bf16 v[112:127], v[156:159], v[48:51], v[112:127]
    ds_read_b64_tr_b16 v[144:145], v12 offset:24576
    ds_read_b64_tr_b16 v[146:147], v12 offset:26624
    s_waitcnt lgkmcnt(9)
    v_mfma_f32_32x32x16_bf16 v[64:79], v[128:131], v[52:55], v[64:79]
    ds_read_b64_tr_b16 v[148:149], v13 offset:24576
    ds_read_b64_tr_b16 v[150:151], v13 offset:26624
    ds_read_b64_tr_b16 v[152:153], v14 offset:24576
    s_waitcnt lgkmcnt(10)
    v_mfma_f32_32x32x16_bf16 v[80:95], v[132:135], v[52:55], v[80:95]
    ds_read_b64_tr_b16 v[154:155], v14 offset:26624
    ds_read_b64_tr_b16 v[156:157], v15 offset:24576
    s_waitcnt lgkmcnt(10)
    v_mfma_f32_32x32x16_bf16 v[96:111], v[136:139], v[52:55], v[96:111]
    ds_read_b64_tr_b16 v[158:159], v15 offset:26624
    s_waitcnt lgkmcnt(9)
    v_mfma_f32_32x32x16_bf16 v[112:127], v[140:143], v[52:55], v[112:127]
    s_waitcnt lgkmcnt(6)
    v_mfma_f32_32x32x16_bf16 v[64:79], v[144:147], v[56:59], v[64:79]
    s_waitcnt lgkmcnt(4)
    v_mfma_f32_32x32x16_bf16 v[80:95], v[148:151], v[56:59], v[80:95]
    s_waitcnt lgkmcnt(0)
    s_barrier
    ds_read_b128 v[216:219], v20
    ds_read_b128 v[220:223], v40
    ds_read_b128 v[224:227], v41
    v_mfma_f32_32x32x16_bf16 v[96:111], v[152:155], v[56:59], v[96:111]
    ds_read_b128 v[228:231], v42
    ds_read_b128 v[232:235], v43
    ds_read_b128 v[236:239], v44
    v_mfma_f32_32x32x16_bf16 v[112:127], v[156:159], v[56:59], v[112:127]
    ds_read_b128 v[240:243], v45
    ds_read_b128 v[244:247], v46
    ds_read_b64_tr_b16 v[128:129], v21 offset:0
    v_cvt_pk_bf16_f32 v168, v64, v65
    v_cvt_pk_bf16_f32 v169, v66, v67
    v_cvt_pk_bf16_f32 v170, v68, v69
    v_cvt_pk_bf16_f32 v171, v70, v71
    v_cvt_pk_bf16_f32 v172, v72, v73
    v_cvt_pk_bf16_f32 v173, v74, v75
    s_waitcnt lgkmcnt(8)
    v_mfma_f32_32x32x16_bf16 v[200:215], v[216:219], v[168:171], 0
    ds_read_b64_tr_b16 v[130:131], v21 offset:1024
    ds_read_b64_tr_b16 v[132:133], v21 offset:4096
    v_cvt_pk_bf16_f32 v174, v76, v77
    v_cvt_pk_bf16_f32 v175, v78, v79
    v_cvt_pk_bf16_f32 v176, v80, v81
    v_cvt_pk_bf16_f32 v177, v82, v83
    v_cvt_pk_bf16_f32 v178, v84, v85
    v_cvt_pk_bf16_f32 v179, v86, v87
    s_waitcnt lgkmcnt(9)
    v_mfma_f32_32x32x16_bf16 v[200:215], v[220:223], v[172:175], v[200:215]
    ds_read_b64_tr_b16 v[134:135], v21 offset:5120
    ds_read_b64_tr_b16 v[136:137], v22 offset:0
    v_cvt_pk_bf16_f32 v180, v88, v89
    v_cvt_pk_bf16_f32 v181, v90, v91
    v_cvt_pk_bf16_f32 v182, v92, v93
    v_cvt_pk_bf16_f32 v183, v94, v95
    v_cvt_pk_bf16_f32 v184, v96, v97
    v_cvt_pk_bf16_f32 v185, v98, v99
    s_waitcnt lgkmcnt(10)
    v_mfma_f32_32x32x16_bf16 v[200:215], v[224:227], v[176:179], v[200:215]
    ds_read_b64_tr_b16 v[138:139], v22 offset:1024
    ds_read_b64_tr_b16 v[140:141], v22 offset:4096
    v_cvt_pk_bf16_f32 v186, v100, v101
    v_cvt_pk_bf16_f32 v187, v102, v103
    v_cvt_pk_bf16_f32 v188, v104, v105
    v_cvt_pk_bf16_f32 v189, v106, v107
    v_cvt_pk_bf16_f32 v190, v108, v109
    v_cvt_pk_bf16_f32 v191, v110, v111
    s_waitcnt lgkmcnt(11)
    v_mfma_f32_32x32x16_bf16 v[200:215], v[228:231], v[180:183], v[200:215]
    ds_read_b64_tr_b16 v[142:143], v22 offset:5120
    v_cvt_pk_bf16_f32 v192, v112, v113
    v_cvt_pk_bf16_f32 v193, v114, v115
    v_cvt_pk_bf16_f32 v194, v116, v117
    v_cvt_pk_bf16_f32 v195, v118, v119
    v_cvt_pk_bf16_f32 v196, v120, v121
    v_cvt_pk_bf16_f32 v197, v122, v123
    s_waitcnt lgkmcnt(11)
    v_mfma_f32_32x32x16_bf16 v[200:215], v[232:235], v[184:187], v[200:215]
    ds_read_b64_tr_b16 v[144:145], v23 offset:0
    v_cvt_pk_bf16_f32 v198, v124, v125
    v_cvt_pk_bf16_f32 v199, v126, v127
    s_waitcnt lgkmcnt(11)
    v_mfma_f32_32x32x16_bf16 v[200:215], v[236:239], v[188:191], v[200:215]
    ds_read_b64_tr_b16 v[146:147], v23 offset:1024
    s_waitcnt lgkmcnt(11)
    v_mfma_f32_32x32x16_bf16 v[200:215], v[240:243], v[192:195], v[200:215]
    ds_read_b64_tr_b16 v[148:149], v23 offset:4096
    s_waitcnt lgkmcnt(11)
    v_mfma_f32_32x32x16_bf16 v[200:215], v[244:247], v[196:199], v[200:215]
    ds_read_b64_tr_b16 v[150:151], v23 offset:5120
    ds_read_b64_tr_b16 v[152:153], v24 offset:0
    ds_read_b64_tr_b16 v[154:155], v24 offset:1024
    ds_read_b64_tr_b16 v[156:157], v24 offset:4096
    s_waitcnt lgkmcnt(14)
    ds_read_b64_tr_b16 v[158:159], v24 offset:5120
    s_waitcnt lgkmcnt(0)
    s_barrier
    s_nop 3
    v_max3_f32 v32, v200, v201, v202
    v_max3_f32 v33, v203, v204, v205
    v_max3_f32 v34, v206, v207, v208
    v_max3_f32 v35, v209, v210, v211
    v_max3_f32 v32, v32, v212, v213
    v_max3_f32 v33, v33, v214, v215
    v_max3_f32 v32, v32, v34, v35
    v_max_f32 v32, v32, v33
    v_mov_b32 v33, v32
    s_nop 1
    v_permlane32_swap_b32 v32, v33
    s_nop 1
    v_max_f32 v32, v32, v33
    v_mul_f32 v32, s94, v32
    v_pk_fma_f32 v[200:201], v[200:201], v[2:3], v[32:33] op_sel_hi:[1,1,0] neg_lo:[0,0,1] neg_hi:[0,0,1]
    v_pk_fma_f32 v[202:203], v[202:203], v[2:3], v[32:33] op_sel_hi:[1,1,0] neg_lo:[0,0,1] neg_hi:[0,0,1]
    v_exp_f32 v200, v200
    v_exp_f32 v201, v201
    v_pk_fma_f32 v[204:205], v[204:205], v[2:3], v[32:33] op_sel_hi:[1,1,0] neg_lo:[0,0,1] neg_hi:[0,0,1]
    v_exp_f32 v202, v202
    v_exp_f32 v203, v203
    v_pk_fma_f32 v[206:207], v[206:207], v[2:3], v[32:33] op_sel_hi:[1,1,0] neg_lo:[0,0,1] neg_hi:[0,0,1]
    v_exp_f32 v204, v204
    v_exp_f32 v205, v205
    v_pk_fma_f32 v[208:209], v[208:209], v[2:3], v[32:33] op_sel_hi:[1,1,0] neg_lo:[0,0,1] neg_hi:[0,0,1]
    v_exp_f32 v206, v206
    v_exp_f32 v207, v207
    v_pk_fma_f32 v[210:211], v[210:211], v[2:3], v[32:33] op_sel_hi:[1,1,0] neg_lo:[0,0,1] neg_hi:[0,0,1]
    v_exp_f32 v208, v208
    v_exp_f32 v209, v209
    v_pk_fma_f32 v[212:213], v[212:213], v[2:3], v[32:33] op_sel_hi:[1,1,0] neg_lo:[0,0,1] neg_hi:[0,0,1]
    v_exp_f32 v210, v210
    v_exp_f32 v211, v211
    v_pk_fma_f32 v[214:215], v[214:215], v[2:3], v[32:33] op_sel_hi:[1,1,0] neg_lo:[0,0,1] neg_hi:[0,0,1]
    v_exp_f32 v212, v212
    v_exp_f32 v213, v213
    v_exp_f32 v214, v214
    v_exp_f32 v215, v215
    v_pk_add_f32 v[32:33], v[200:201], v[202:203]
    v_pk_add_f32 v[34:35], v[204:205], v[206:207]
    v_pk_add_f32 v[32:33], v[32:33], v[208:209]
    v_pk_add_f32 v[34:35], v[34:35], v[210:211]
    v_pk_add_f32 v[32:33], v[32:33], v[212:213]
    v_pk_add_f32 v[34:35], v[34:35], v[214:215]
    v_pk_add_f32 v[32:33], v[32:33], v[34:35]
    v_add_f32 v32, v32, v33
    v_mov_b32 v33, v32
    s_nop 1
    v_permlane32_swap_b32 v32, v33
    s_nop 1
    v_add_f32 v32, v32, v33
    v_rcp_f32 v32, v32
    s_nop 0
    v_pk_mul_f32 v[200:201], v[200:201], v[32:33] op_sel_hi:[1,0]
    v_pk_mul_f32 v[202:203], v[202:203], v[32:33] op_sel_hi:[1,0]
    v_cvt_pk_bf16_f32 v160, v200, v201
    v_pk_mul_f32 v[204:205], v[204:205], v[32:33] op_sel_hi:[1,0]
    v_cvt_pk_bf16_f32 v161, v202, v203
    v_pk_mul_f32 v[206:207], v[206:207], v[32:33] op_sel_hi:[1,0]
    v_cvt_pk_bf16_f32 v162, v204, v205
    v_pk_mul_f32 v[208:209], v[208:209], v[32:33] op_sel_hi:[1,0]
    v_cvt_pk_bf16_f32 v163, v206, v207
    v_pk_mul_f32 v[210:211], v[210:211], v[32:33] op_sel_hi:[1,0]
    v_cvt_pk_bf16_f32 v164, v208, v209
    v_pk_mul_f32 v[212:213], v[212:213], v[32:33] op_sel_hi:[1,0]
    v_cvt_pk_bf16_f32 v165, v210, v211
    v_pk_mul_f32 v[214:215], v[214:215], v[32:33] op_sel_hi:[1,0]
    v_cvt_pk_bf16_f32 v166, v212, v213
    v_cvt_pk_bf16_f32 v167, v214, v215
    s_nop 1
    v_mfma_f32_32x32x16_bf16 v[64:79], v[128:131], v[160:163], 0
    s_barrier
    ds_read_b64_tr_b16 v[128:129], v27 offset:0
    ds_read_b64_tr_b16 v[130:131], v27 offset:512
    v_mfma_f32_32x32x16_bf16 v[64:79], v[132:135], v[164:167], v[64:79]
    ds_read_b64_tr_b16 v[132:133], v27 offset:2048
    ds_read_b64_tr_b16 v[134:135], v27 offset:2560
    v_mfma_f32_32x32x16_bf16 v[80:95], v[136:139], v[160:163], 0
    ds_read_b64_tr_b16 v[136:137], v27 offset:4096
    ds_read_b64_tr_b16 v[138:139], v27 offset:4608
    v_mfma_f32_32x32x16_bf16 v[80:95], v[140:143], v[164:167], v[80:95]
    ds_read_b64_tr_b16 v[140:141], v27 offset:6144
    ds_read_b64_tr_b16 v[142:143], v27 offset:6656
    v_mfma_f32_32x32x16_bf16 v[96:111], v[144:147], v[160:163], 0
    ds_read_b64_tr_b16 v[144:145], v27 offset:8192
    ds_read_b64_tr_b16 v[146:147], v27 offset:8704
    v_mfma_f32_32x32x16_bf16 v[96:111], v[148:151], v[164:167], v[96:111]
    ds_read_b64_tr_b16 v[148:149], v27 offset:10240
    ds_read_b64_tr_b16 v[150:151], v27 offset:10752
    v_cvt_pk_bf16_f32 v168, v64, v65
    v_cvt_pk_bf16_f32 v169, v66, v67
    v_cvt_pk_bf16_f32 v170, v68, v69
    v_cvt_pk_bf16_f32 v171, v70, v71
    ds_write_b128 v25, v[168:171] offset:0
    v_cvt_pk_bf16_f32 v172, v72, v73
    v_mfma_f32_32x32x16_bf16 v[112:127], v[152:155], v[160:163], 0
    v_cvt_pk_bf16_f32 v173, v74, v75
    v_cvt_pk_bf16_f32 v174, v76, v77
    v_cvt_pk_bf16_f32 v175, v78, v79
    ds_write_b128 v25, v[172:175] offset:1024
    v_cvt_pk_bf16_f32 v176, v80, v81
    v_cvt_pk_bf16_f32 v177, v82, v83
    v_mfma_f32_32x32x16_bf16 v[112:127], v[156:159], v[164:167], v[112:127]
    v_cvt_pk_bf16_f32 v178, v84, v85
    v_cvt_pk_bf16_f32 v179, v86, v87
    ds_write_b128 v25, v[176:179] offset:2048
    v_cvt_pk_bf16_f32 v180, v88, v89
    v_cvt_pk_bf16_f32 v181, v90, v91
    v_cvt_pk_bf16_f32 v182, v92, v93
    s_waitcnt lgkmcnt(13)
    v_mfma_f32_32x32x16_bf16 v[64:79], v[128:131], v[168:171], 0
    v_cvt_pk_bf16_f32 v183, v94, v95
    ds_write_b128 v25, v[180:183] offset:3072
    v_cvt_pk_bf16_f32 v184, v96, v97
    v_cvt_pk_bf16_f32 v185, v98, v99
    v_cvt_pk_bf16_f32 v186, v100, v101
    s_waitcnt lgkmcnt(12)
    v_mfma_f32_32x32x16_bf16 v[64:79], v[132:135], v[172:175], v[64:79]
    v_cvt_pk_bf16_f32 v187, v102, v103
    ds_write_b128 v25, v[184:187] offset:4096
    v_cvt_pk_bf16_f32 v188, v104, v105
    v_cvt_pk_bf16_f32 v189, v106, v107
    v_cvt_pk_bf16_f32 v190, v108, v109
    s_waitcnt lgkmcnt(11)
    v_mfma_f32_32x32x16_bf16 v[64:79], v[136:139], v[176:179], v[64:79]
    ds_read_b64_tr_b16 v[152:153], v27 offset:12288
    v_cvt_pk_bf16_f32 v191, v110, v111
    ds_write_b128 v25, v[188:191] offset:5120
    v_cvt_pk_bf16_f32 v192, v112, v113
    v_cvt_pk_bf16_f32 v193, v114, v115
    v_cvt_pk_bf16_f32 v194, v116, v117
    s_waitcnt lgkmcnt(11)
    v_mfma_f32_32x32x16_bf16 v[64:79], v[140:143], v[180:183], v[64:79]
    ds_read_b64_tr_b16 v[154:155], v27 offset:12800
    v_cvt_pk_bf16_f32 v195, v118, v119
    ds_write_b128 v25, v[192:195] offset:6144
    v_cvt_pk_bf16_f32 v196, v120, v121
    v_cvt_pk_bf16_f32 v197, v122, v123
    v_cvt_pk_bf16_f32 v198, v124, v125
    s_waitcnt lgkmcnt(11)
    v_mfma_f32_32x32x16_bf16 v[64:79], v[144:147], v[184:187], v[64:79]
    ds_read_b64_tr_b16 v[156:157], v27 offset:14336
    v_cvt_pk_bf16_f32 v199, v126, v127
    ds_write_b128 v25, v[196:199] offset:7168
    s_waitcnt lgkmcnt(11)
    v_mfma_f32_32x32x16_bf16 v[64:79], v[148:151], v[188:191], v[64:79]
    ds_read_b64_tr_b16 v[158:159], v27 offset:14848
    s_waitcnt lgkmcnt(0)
    s_barrier
    ds_read_b128 v[216:219], v26 offset:0
    ds_read_b64_tr_b16 v[128:129], v28 offset:0
    v_mfma_f32_32x32x16_bf16 v[64:79], v[152:155], v[192:195], v[64:79]
    ds_read_b64_tr_b16 v[130:131], v28 offset:512
    ds_read_b128 v[220:223], v26 offset:1024
    ds_read_b64_tr_b16 v[132:133], v28 offset:2048
    v_mfma_f32_32x32x16_bf16 v[64:79], v[156:159], v[196:199], v[64:79]
    ds_read_b64_tr_b16 v[134:135], v28 offset:2560
    ds_read_b128 v[224:227], v26 offset:2048
    ds_read_b64_tr_b16 v[136:137], v28 offset:4096
    s_waitcnt lgkmcnt(5)
    v_mfma_f32_32x32x16_bf16 v[64:79], v[128:131], v[216:219], v[64:79]
    ds_read_b64_tr_b16 v[138:139], v28 offset:4608
    ds_read_b128 v[228:231], v26 offset:3072
    ds_read_b64_tr_b16 v[140:141], v28 offset:6144
    s_waitcnt lgkmcnt(5)
    v_mfma_f32_32x32x16_bf16 v[64:79], v[132:135], v[220:223], v[64:79]
    ds_read_b64_tr_b16 v[142:143], v28 offset:6656
    ds_read_b128 v[232:235], v26 offset:4096
    ds_read_b64_tr_b16 v[144:145], v28 offset:8192
    s_waitcnt lgkmcnt(5)
    v_mfma_f32_32x32x16_bf16 v[64:79], v[136:139], v[224:227], v[64:79]
    ds_read_b64_tr_b16 v[146:147], v28 offset:8704
    ds_read_b128 v[236:239], v26 offset:5120
    ds_read_b64_tr_b16 v[148:149], v28 offset:10240
    s_waitcnt lgkmcnt(5)
    v_mfma_f32_32x32x16_bf16 v[64:79], v[140:143], v[228:231], v[64:79]
    ds_read_b64_tr_b16 v[150:151], v28 offset:10752
    ds_read_b128 v[240:243], v26 offset:6144
    ds_read_b64_tr_b16 v[152:153], v28 offset:12288
    s_waitcnt lgkmcnt(5)
    v_mfma_f32_32x32x16_bf16 v[64:79], v[144:147], v[232:235], v[64:79]
    ds_read_b64_tr_b16 v[154:155], v28 offset:12800
    ds_read_b128 v[244:247], v26 offset:7168
    ds_read_b64_tr_b16 v[156:157], v28 offset:14336
    s_waitcnt lgkmcnt(5)
    v_mfma_f32_32x32x16_bf16 v[64:79], v[148:151], v[236:239], v[64:79]
    ds_read_b64_tr_b16 v[158:159], v28 offset:14848
    s_waitcnt lgkmcnt(0)
    s_barrier
    ds_read_b64_tr_b16 v[128:129], v27 offset:32768
    ds_read_b64_tr_b16 v[130:131], v27 offset:33280
    v_mfma_f32_32x32x16_bf16 v[64:79], v[152:155], v[240:243], v[64:79]
    ds_read_b64_tr_b16 v[132:133], v27 offset:34816
    ds_read_b64_tr_b16 v[134:135], v27 offset:35328
    ds_read_b64_tr_b16 v[136:137], v27 offset:36864
    v_mfma_f32_32x32x16_bf16 v[64:79], v[156:159], v[244:247], v[64:79]
    ds_read_b64_tr_b16 v[138:139], v27 offset:37376
    ds_read_b64_tr_b16 v[140:141], v27 offset:38912
    ds_read_b64_tr_b16 v[142:143], v27 offset:39424
    s_waitcnt lgkmcnt(6)
    v_mfma_f32_32x32x16_bf16 v[80:95], v[128:131], v[168:171], 0
    ds_read_b64_tr_b16 v[144:145], v27 offset:40960
    ds_read_b64_tr_b16 v[146:147], v27 offset:41472
    ds_read_b64_tr_b16 v[148:149], v27 offset:43008
    s_waitcnt lgkmcnt(7)
    v_mfma_f32_32x32x16_bf16 v[80:95], v[132:135], v[172:175], v[80:95]
    ds_read_b64_tr_b16 v[150:151], v27 offset:43520
    ds_read_b64_tr_b16 v[152:153], v27 offset:45056
    ds_read_b64_tr_b16 v[154:155], v27 offset:45568
    v_cvt_pk_bf16_f32 v96, v64, v65
    v_cvt_pk_bf16_f32 v97, v66, v67
    s_waitcnt lgkmcnt(8)
    v_mfma_f32_32x32x16_bf16 v[80:95], v[136:139], v[176:179], v[80:95]
    ds_read_b64_tr_b16 v[156:157], v27 offset:47104
    ds_read_b64_tr_b16 v[158:159], v27 offset:47616
    ds_read_b64_tr_b16 v[128:129], v28 offset:32768
    v_cvt_pk_bf16_f32 v98, v68, v69
    v_cvt_pk_bf16_f32 v99, v70, v71
    s_waitcnt lgkmcnt(9)
    v_mfma_f32_32x32x16_bf16 v[80:95], v[140:143], v[180:183], v[80:95]
    ds_read_b64_tr_b16 v[130:131], v28 offset:33280
    ds_read_b64_tr_b16 v[132:133], v28 offset:34816
    ds_read_b64_tr_b16 v[134:135], v28 offset:35328
    v_cvt_pk_bf16_f32 v100, v72, v73
    v_cvt_pk_bf16_f32 v101, v74, v75
    s_waitcnt lgkmcnt(10)
    v_mfma_f32_32x32x16_bf16 v[80:95], v[144:147], v[184:187], v[80:95]
    ds_read_b64_tr_b16 v[136:137], v28 offset:36864
    ds_read_b64_tr_b16 v[138:139], v28 offset:37376
    v_cvt_pk_bf16_f32 v102, v76, v77
    v_cvt_pk_bf16_f32 v103, v78, v79
    s_waitcnt lgkmcnt(10)
    v_mfma_f32_32x32x16_bf16 v[80:95], v[148:151], v[188:191], v[80:95]
    ds_read_b64_tr_b16 v[140:141], v28 offset:38912
    ds_read_b64_tr_b16 v[142:143], v28 offset:39424
    s_waitcnt lgkmcnt(10)
    v_mfma_f32_32x32x16_bf16 v[80:95], v[152:155], v[192:195], v[80:95]
    ds_read_b64_tr_b16 v[144:145], v28 offset:40960
    ds_read_b64_tr_b16 v[146:147], v28 offset:41472
    s_add_u32 s88, s62, 0
    s_cmp_ge_u32 s88, 9
    s_cselect_b32 s7, 9, 0
    s_sub_u32 s88, s88, s7
    s_mul_i32 s88, s88, 4096
    s_mov_b64 exec, s[50:51]
    buffer_store_dwordx4 v[96:99], v31, s[28:31], s88 offen offset:0 sc1
    s_mov_b64 exec, -1
    s_waitcnt lgkmcnt(10)
    v_mfma_f32_32x32x16_bf16 v[80:95], v[156:159], v[196:199], v[80:95]
    ds_read_b64_tr_b16 v[148:149], v28 offset:43008
    ds_read_b64_tr_b16 v[150:151], v28 offset:43520
    s_mov_b64 exec, s[50:51]
    buffer_store_dwordx4 v[100:103], v31, s[28:31], s88 offen offset:1024 sc1
    s_mov_b64 exec, -1
    s_mov_b64 exec, s[52:53]
    s_cbranch_execz L_kp0
    ds_write_b128 v4, v[96:99] offset:0
    ds_write_b128 v4, v[100:103] offset:256
L_kp0:
    s_mov_b64 exec, -1
    s_waitcnt lgkmcnt(10)
    v_mfma_f32_32x32x16_bf16 v[80:95], v[128:131], v[216:219], v[80:95]
    ds_read_b64_tr_b16 v[152:153], v28 offset:45056
    ds_read_b64_tr_b16 v[154:155], v28 offset:45568
    s_waitcnt lgkmcnt(10)
    v_mfma_f32_32x32x16_bf16 v[80:95], v[132:135], v[220:223], v[80:95]
    ds_read_b64_tr_b16 v[156:157], v28 offset:47104
    ds_read_b64_tr_b16 v[158:159], v28 offset:47616
    s_waitcnt lgkmcnt(10)
    v_mfma_f32_32x32x16_bf16 v[80:95], v[136:139], v[224:227], v[80:95]
    s_waitcnt lgkmcnt(8)
    v_mfma_f32_32x32x16_bf16 v[80:95], v[140:143], v[228:231], v[80:95]
    s_waitcnt lgkmcnt(6)
    v_mfma_f32_32x32x16_bf16 v[80:95], v[144:147], v[232:235], v[80:95]
    s_waitcnt lgkmcnt(0)
    s_barrier
    ds_read_b64_tr_b16 v[128:129], v29 offset:0
    ds_read_b64_tr_b16 v[130:131], v29 offset:512
    ds_read_b64_tr_b16 v[132:133], v29 offset:2048
    v_mfma_f32_32x32x16_bf16 v[80:95], v[148:151], v[236:239], v[80:95]
    ds_read_b64_tr_b16 v[134:135], v29 offset:2560
    ds_read_b64_tr_b16 v[136:137], v29 offset:4096
    ds_read_b64_tr_b16 v[138:139], v29 offset:4608
    v_mfma_f32_32x32x16_bf16 v[80:95], v[152:155], v[240:243], v[80:95]
    ds_read_b64_tr_b16 v[140:141], v29 offset:6144
    ds_read_b64_tr_b16 v[142:143], v29 offset:6656
    ds_read_b64_tr_b16 v[144:145], v29 offset:8192
    v_mfma_f32_32x32x16_bf16 v[80:95], v[156:159], v[244:247], v[80:95]
    ds_read_b64_tr_b16 v[146:147], v29 offset:8704
    ds_read_b64_tr_b16 v[148:149], v29 offset:10240
    ds_read_b64_tr_b16 v[150:151], v29 offset:10752
    s_waitcnt lgkmcnt(10)
    v_mfma_f32_32x32x16_bf16 v[64:79], v[128:131], v[168:171], 0
    ds_read_b64_tr_b16 v[152:153], v29 offset:12288
    ds_read_b64_tr_b16 v[154:155], v29 offset:12800
    s_waitcnt lgkmcnt(10)
    v_mfma_f32_32x32x16_bf16 v[64:79], v[132:135], v[172:175], v[64:79]
    ds_read_b64_tr_b16 v[156:157], v29 offset:14336
    ds_read_b64_tr_b16 v[158:159], v29 offset:14848
    s_waitcnt lgkmcnt(10)
    v_mfma_f32_32x32x16_bf16 v[64:79], v[136:139], v[176:179], v[64:79]
    ds_read_b64_tr_b16 v[128:129], v30 offset:0
    ds_read_b64_tr_b16 v[130:131], v30 offset:512
    v_cvt_pk_bf16_f32 v104, v80, v81
    v_cvt_pk_bf16_f32 v105, v82, v83
    s_waitcnt lgkmcnt(10)
    v_mfma_f32_32x32x16_bf16 v[64:79], v[140:143], v[180:183], v[64:79]
    ds_read_b64_tr_b16 v[132:133], v30 offset:2048
    ds_read_b64_tr_b16 v[134:135], v30 offset:2560
    v_cvt_pk_bf16_f32 v106, v84, v85
    v_cvt_pk_bf16_f32 v107, v86, v87
    s_waitcnt lgkmcnt(10)
    v_mfma_f32_32x32x16_bf16 v[64:79], v[144:147], v[184:187], v[64:79]
    ds_read_b64_tr_b16 v[136:137], v30 offset:4096
    ds_read_b64_tr_b16 v[138:139], v30 offset:4608
    v_cvt_pk_bf16_f32 v108, v88, v89
    v_cvt_pk_bf16_f32 v109, v90, v91
    s_waitcnt lgkmcnt(10)
    v_mfma_f32_32x32x16_bf16 v[64:79], v[148:151], v[188:191], v[64:79]
    ds_read_b64_tr_b16 v[140:141], v30 offset:6144
    ds_read_b64_tr_b16 v[142:143], v30 offset:6656
    v_cvt_pk_bf16_f32 v110, v92, v93
    v_cvt_pk_bf16_f32 v111, v94, v95
    s_waitcnt lgkmcnt(10)
    v_mfma_f32_32x32x16_bf16 v[64:79], v[152:155], v[192:195], v[64:79]
    ds_read_b64_tr_b16 v[144:145], v30 offset:8192
    ds_read_b64_tr_b16 v[146:147], v30 offset:8704
    s_add_u32 s88, s62, 1
    s_cmp_ge_u32 s88, 9
    s_cselect_b32 s7, 9, 0
    s_sub_u32 s88, s88, s7
    s_mul_i32 s88, s88, 4096
    s_mov_b64 exec, s[50:51]
    buffer_store_dwordx4 v[104:107], v31, s[28:31], s88 offen offset:0 sc1
    s_mov_b64 exec, -1
    s_waitcnt lgkmcnt(10)
    v_mfma_f32_32x32x16_bf16 v[64:79], v[156:159], v[196:199], v[64:79]
    ds_read_b64_tr_b16 v[148:149], v30 offset:10240
    ds_read_b64_tr_b16 v[150:151], v30 offset:10752
    s_mov_b64 exec, s[50:51]
    buffer_store_dwordx4 v[108:111], v31, s[28:31], s88 offen offset:1024 sc1
    s_mov_b64 exec, -1
    s_mov_b64 exec, s[52:53]
    s_cbranch_execz L_kp1
    ds_write_b128 v4, v[104:107] offset:512
    ds_write_b128 v4, v[108:111] offset:768
L_kp1:
    s_mov_b64 exec, -1
    s_waitcnt lgkmcnt(10)
    v_mfma_f32_32x32x16_bf16 v[64:79], v[128:131], v[216:219], v[64:79]
    ds_read_b64_tr_b16 v[152:153], v30 offset:12288
    ds_read_b64_tr_b16 v[154:155], v30 offset:12800
    s_waitcnt lgkmcnt(10)
    v_mfma_f32_32x32x16_bf16 v[64:79], v[132:135], v[220:223], v[64:79]
    ds_read_b64_tr_b16 v[156:157], v30 offset:14336
    ds_read_b64_tr_b16 v[158:159], v30 offset:14848
    s_waitcnt lgkmcnt(10)
    v_mfma_f32_32x32x16_bf16 v[64:79], v[136:139], v[224:227], v[64:79]
    s_waitcnt lgkmcnt(8)
    v_mfma_f32_32x32x16_bf16 v[64:79], v[140:143], v[228:231], v[64:79]
    s_waitcnt lgkmcnt(6)
    v_mfma_f32_32x32x16_bf16 v[64:79], v[144:147], v[232:235], v[64:79]
    s_waitcnt lgkmcnt(0)
    s_barrier
    ds_read_b64_tr_b16 v[128:129], v29 offset:32768
    ds_read_b64_tr_b16 v[130:131], v29 offset:33280
    ds_read_b64_tr_b16 v[132:133], v29 offset:34816
    v_mfma_f32_32x32x16_bf16 v[64:79], v[148:151], v[236:239], v[64:79]
    ds_read_b64_tr_b16 v[134:135], v29 offset:35328
    ds_read_b64_tr_b16 v[136:137], v29 offset:36864
    ds_read_b64_tr_b16 v[138:139], v29 offset:37376
    v_mfma_f32_32x32x16_bf16 v[64:79], v[152:155], v[240:243], v[64:79]
    ds_read_b64_tr_b16 v[140:141], v29 offset:38912
    ds_read_b64_tr_b16 v[142:143], v29 offset:39424
    ds_read_b64_tr_b16 v[144:145], v29 offset:40960
    v_mfma_f32_32x32x16_bf16 v[64:79], v[156:159], v[244:247], v[64:79]
    ds_read_b64_tr_b16 v[146:147], v29 offset:41472
    ds_read_b64_tr_b16 v[148:149], v29 offset:43008
    ds_read_b64_tr_b16 v[150:151], v29 offset:43520
    s_waitcnt lgkmcnt(10)
    v_mfma_f32_32x32x16_bf16 v[80:95], v[128:131], v[168:171], 0
    ds_read_b64_tr_b16 v[152:153], v29 offset:45056
    ds_read_b64_tr_b16 v[154:155], v29 offset:45568
    s_waitcnt lgkmcnt(10)
    v_mfma_f32_32x32x16_bf16 v[80:95], v[132:135], v[172:175], v[80:95]
    ds_read_b64_tr_b16 v[156:157], v29 offset:47104
    ds_read_b64_tr_b16 v[158:159], v29 offset:47616
    s_waitcnt lgkmcnt(10)
    v_mfma_f32_32x32x16_bf16 v[80:95], v[136:139], v[176:179], v[80:95]
    ds_read_b64_tr_b16 v[128:129], v30 offset:32768
    ds_read_b64_tr_b16 v[130:131], v30 offset:33280
    v_cvt_pk_bf16_f32 v112, v64, v65
    v_cvt_pk_bf16_f32 v113, v66, v67
    s_waitcnt lgkmcnt(10)
    v_mfma_f32_32x32x16_bf16 v[80:95], v[140:143], v[180:183], v[80:95]
    ds_read_b64_tr_b16 v[132:133], v30 offset:34816
    ds_read_b64_tr_b16 v[134:135], v30 offset:35328
    v_cvt_pk_bf16_f32 v114, v68, v69
    v_cvt_pk_bf16_f32 v115, v70, v71
    s_waitcnt lgkmcnt(10)
    v_mfma_f32_32x32x16_bf16 v[80:95], v[144:147], v[184:187], v[80:95]
    ds_read_b64_tr_b16 v[136:137], v30 offset:36864
    ds_read_b64_tr_b16 v[138:139], v30 offset:37376
    v_cvt_pk_bf16_f32 v116, v72, v73
    v_cvt_pk_bf16_f32 v117, v74, v75
    s_waitcnt lgkmcnt(10)
    v_mfma_f32_32x32x16_bf16 v[80:95], v[148:151], v[188:191], v[80:95]
    ds_read_b64_tr_b16 v[140:141], v30 offset:38912
    ds_read_b64_tr_b16 v[142:143], v30 offset:39424
    v_cvt_pk_bf16_f32 v118, v76, v77
    v_cvt_pk_bf16_f32 v119, v78, v79
    s_waitcnt lgkmcnt(10)
    v_mfma_f32_32x32x16_bf16 v[80:95], v[152:155], v[192:195], v[80:95]
    ds_read_b64_tr_b16 v[144:145], v30 offset:40960
    ds_read_b64_tr_b16 v[146:147], v30 offset:41472
    s_add_u32 s88, s62, 2
    s_cmp_ge_u32 s88, 9
    s_cselect_b32 s7, 9, 0
    s_sub_u32 s88, s88, s7
    s_mul_i32 s88, s88, 4096
    s_mov_b64 exec, s[50:51]
    buffer_store_dwordx4 v[112:115], v31, s[28:31], s88 offen offset:0 sc1
    s_mov_b64 exec, -1
    s_waitcnt lgkmcnt(10)
    v_mfma_f32_32x32x16_bf16 v[80:95], v[156:159], v[196:199], v[80:95]
    ds_read_b64_tr_b16 v[148:149], v30 offset:43008
    ds_read_b64_tr_b16 v[150:151], v30 offset:43520
    s_mov_b64 exec, s[50:51]
    buffer_store_dwordx4 v[116:119], v31, s[28:31], s88 offen offset:1024 sc1
    s_mov_b64 exec, -1
    s_mov_b64 exec, s[52:53]
    s_cbranch_execz L_kp2
    ds_write_b128 v4, v[112:115] offset:1024
    ds_write_b128 v4, v[116:119] offset:1280
L_kp2:
    s_mov_b64 exec, -1
    s_waitcnt lgkmcnt(10)
    v_mfma_f32_32x32x16_bf16 v[80:95], v[128:131], v[216:219], v[80:95]
    ds_read_b64_tr_b16 v[152:153], v30 offset:45056
    ds_read_b64_tr_b16 v[154:155], v30 offset:45568
    s_waitcnt lgkmcnt(10)
    v_mfma_f32_32x32x16_bf16 v[80:95], v[132:135], v[220:223], v[80:95]
    ds_read_b64_tr_b16 v[156:157], v30 offset:47104
    ds_read_b64_tr_b16 v[158:159], v30 offset:47616
    s_waitcnt lgkmcnt(10)
    v_mfma_f32_32x32x16_bf16 v[80:95], v[136:139], v[224:227], v[80:95]
    s_waitcnt lgkmcnt(8)
    v_mfma_f32_32x32x16_bf16 v[80:95], v[140:143], v[228:231], v[80:95]
    s_waitcnt lgkmcnt(6)
    v_mfma_f32_32x32x16_bf16 v[80:95], v[144:147], v[232:235], v[80:95]
    s_waitcnt lgkmcnt(0)
    s_barrier
    ds_read_b64_tr_b16 v[128:129], v27 offset:0
    ds_read_b64_tr_b16 v[130:131], v27 offset:512
    ds_read_b64_tr_b16 v[132:133], v27 offset:2048
    v_mfma_f32_32x32x16_bf16 v[80:95], v[148:151], v[236:239], v[80:95]
    ds_read_b64_tr_b16 v[134:135], v27 offset:2560
    ds_read_b64_tr_b16 v[136:137], v27 offset:4096
    ds_read_b64_tr_b16 v[138:139], v27 offset:4608
    v_mfma_f32_32x32x16_bf16 v[80:95], v[152:155], v[240:243], v[80:95]
    ds_read_b64_tr_b16 v[140:141], v27 offset:6144
    ds_read_b64_tr_b16 v[142:143], v27 offset:6656
    ds_read_b64_tr_b16 v[144:145], v27 offset:8192
    v_mfma_f32_32x32x16_bf16 v[80:95], v[156:159], v[244:247], v[80:95]
    ds_read_b64_tr_b16 v[146:147], v27 offset:8704
    ds_read_b64_tr_b16 v[148:149], v27 offset:10240
    ds_read_b64_tr_b16 v[150:151], v27 offset:10752
    s_waitcnt lgkmcnt(10)
    v_mfma_f32_32x32x16_bf16 v[64:79], v[128:131], v[168:171], 0
    ds_read_b64_tr_b16 v[152:153], v27 offset:12288
    ds_read_b64_tr_b16 v[154:155], v27 offset:12800
    s_waitcnt lgkmcnt(10)
    v_mfma_f32_32x32x16_bf16 v[64:79], v[132:135], v[172:175], v[64:79]
    ds_read_b64_tr_b16 v[156:157], v27 offset:14336
    ds_read_b64_tr_b16 v[158:159], v27 offset:14848
    s_waitcnt lgkmcnt(10)
    v_mfma_f32_32x32x16_bf16 v[64:79], v[136:139], v[176:179], v[64:79]
    ds_read_b64_tr_b16 v[128:129], v28 offset:0
    ds_read_b64_tr_b16 v[130:131], v28 offset:512
    v_cvt_pk_bf16_f32 v120, v80, v81
    v_cvt_pk_bf16_f32 v121, v82, v83
    s_waitcnt lgkmcnt(10)
    v_mfma_f32_32x32x16_bf16 v[64:79], v[140:143], v[180:183], v[64:79]
    ds_read_b64_tr_b16 v[132:133], v28 offset:2048
    ds_read_b64_tr_b16 v[134:135], v28 offset:2560
    v_cvt_pk_bf16_f32 v122, v84, v85
    v_cvt_pk_bf16_f32 v123, v86, v87
    s_waitcnt lgkmcnt(10)
    v_mfma_f32_32x32x16_bf16 v[64:79], v[144:147], v[184:187], v[64:79]
    ds_read_b64_tr_b16 v[136:137], v28 offset:4096
    ds_read_b64_tr_b16 v[138:139], v28 offset:4608
    v_cvt_pk_bf16_f32 v124, v88, v89
    v_cvt_pk_bf16_f32 v125, v90, v91
    s_waitcnt lgkmcnt(10)
    v_mfma_f32_32x32x16_bf16 v[64:79], v[148:151], v[188:191], v[64:79]
    ds_read_b64_tr_b16 v[140:141], v28 offset:6144
    ds_read_b64_tr_b16 v[142:143], v28 offset:6656
    v_cvt_pk_bf16_f32 v126, v92, v93
    v_cvt_pk_bf16_f32 v127, v94, v95
    s_waitcnt lgkmcnt(10)
    v_mfma_f32_32x32x16_bf16 v[64:79], v[152:155], v[192:195], v[64:79]
    ds_read_b64_tr_b16 v[144:145], v28 offset:8192
    ds_read_b64_tr_b16 v[146:147], v28 offset:8704
    s_add_u32 s88, s62, 3
    s_cmp_ge_u32 s88, 9
    s_cselect_b32 s7, 9, 0
    s_sub_u32 s88, s88, s7
    s_mul_i32 s88, s88, 4096
    s_mov_b64 exec, s[50:51]
    buffer_store_dwordx4 v[120:123], v31, s[28:31], s88 offen offset:0 sc1
    s_mov_b64 exec, -1
    s_waitcnt lgkmcnt(10)
    v_mfma_f32_32x32x16_bf16 v[64:79], v[156:159], v[196:199], v[64:79]
    ds_read_b64_tr_b16 v[148:149], v28 offset:10240
    ds_read_b64_tr_b16 v[150:151], v28 offset:10752
    s_mov_b64 exec, s[50:51]
    buffer_store_dwordx4 v[124:127], v31, s[28:31], s88 offen offset:1024 sc1
    s_mov_b64 exec, -1
    s_mov_b64 exec, s[52:53]
    s_cbranch_execz L_kp3
    ds_write_b128 v4, v[120:123] offset:1536
    ds_write_b128 v4, v[124:127] offset:1792
L_kp3:
    s_mov_b64 exec, -1
    s_waitcnt lgkmcnt(10)
    v_mfma_f32_32x32x16_bf16 v[64:79], v[128:131], v[216:219], v[64:79]
    ds_read_b64_tr_b16 v[152:153], v28 offset:12288
    ds_read_b64_tr_b16 v[154:155], v28 offset:12800
    s_waitcnt lgkmcnt(10)
    v_mfma_f32_32x32x16_bf16 v[64:79], v[132:135], v[220:223], v[64:79]
    ds_read_b64_tr_b16 v[156:157], v28 offset:14336
    ds_read_b64_tr_b16 v[158:159], v28 offset:14848
    s_waitcnt lgkmcnt(10)
    v_mfma_f32_32x32x16_bf16 v[64:79], v[136:139], v[224:227], v[64:79]
    s_waitcnt lgkmcnt(8)
    v_mfma_f32_32x32x16_bf16 v[64:79], v[140:143], v[228:231], v[64:79]
    s_waitcnt lgkmcnt(6)
    v_mfma_f32_32x32x16_bf16 v[64:79], v[144:147], v[232:235], v[64:79]
    s_waitcnt lgkmcnt(0)
    s_barrier
    ds_read_b64_tr_b16 v[128:129], v27 offset:32768
    ds_read_b64_tr_b16 v[130:131], v27 offset:33280
    ds_read_b64_tr_b16 v[132:133], v27 offset:34816
    v_mfma_f32_32x32x16_bf16 v[64:79], v[148:151], v[236:239], v[64:79]
    ds_read_b64_tr_b16 v[134:135], v27 offset:35328
    ds_read_b64_tr_b16 v[136:137], v27 offset:36864
    ds_read_b64_tr_b16 v[138:139], v27 offset:37376
    v_mfma_f32_32x32x16_bf16 v[64:79], v[152:155], v[240:243], v[64:79]
    ds_read_b64_tr_b16 v[140:141], v27 offset:38912
    ds_read_b64_tr_b16 v[142:143], v27 offset:39424
    ds_read_b64_tr_b16 v[144:145], v27 offset:40960
    v_mfma_f32_32x32x16_bf16 v[64:79], v[156:159], v[244:247], v[64:79]
    ds_read_b64_tr_b16 v[146:147], v27 offset:41472
    ds_read_b64_tr_b16 v[148:149], v27 offset:43008
    ds_read_b64_tr_b16 v[150:151], v27 offset:43520
    s_waitcnt lgkmcnt(10)
    v_mfma_f32_32x32x16_bf16 v[80:95], v[128:131], v[168:171], 0
    ds_read_b64_tr_b16 v[152:153], v27 offset:45056
    ds_read_b64_tr_b16 v[154:155], v27 offset:45568
    s_waitcnt lgkmcnt(10)
    v_mfma_f32_32x32x16_bf16 v[80:95], v[132:135], v[172:175], v[80:95]
    ds_read_b64_tr_b16 v[156:157], v27 offset:47104
    ds_read_b64_tr_b16 v[158:159], v27 offset:47616
    s_waitcnt lgkmcnt(10)
    v_mfma_f32_32x32x16_bf16 v[80:95], v[136:139], v[176:179], v[80:95]
    ds_read_b64_tr_b16 v[128:129], v28 offset:32768
    ds_read_b64_tr_b16 v[130:131], v28 offset:33280
    v_cvt_pk_bf16_f32 v48, v64, v65
    v_cvt_pk_bf16_f32 v49, v66, v67
    s_waitcnt lgkmcnt(10)
    v_mfma_f32_32x32x16_bf16 v[80:95], v[140:143], v[180:183], v[80:95]
    ds_read_b64_tr_b16 v[132:133], v28 offset:34816
    ds_read_b64_tr_b16 v[134:135], v28 offset:35328
    v_cvt_pk_bf16_f32 v50, v68, v69
    v_cvt_pk_bf16_f32 v51, v70, v71
    s_waitcnt lgkmcnt(10)
    v_mfma_f32_32x32x16_bf16 v[80:95], v[144:147], v[184:187], v[80:95]
    ds_read_b64_tr_b16 v[136:137], v28 offset:36864
    ds_read_b64_tr_b16 v[138:139], v28 offset:37376
    v_cvt_pk_bf16_f32 v52, v72, v73
    v_cvt_pk_bf16_f32 v53, v74, v75
    s_waitcnt lgkmcnt(10)
    v_mfma_f32_32x32x16_bf16 v[80:95], v[148:151], v[188:191], v[80:95]
    ds_read_b64_tr_b16 v[140:141], v28 offset:38912
    ds_read_b64_tr_b16 v[142:143], v28 offset:39424
    v_cvt_pk_bf16_f32 v54, v76, v77
    v_cvt_pk_bf16_f32 v55, v78, v79
    s_waitcnt lgkmcnt(10)
    v_mfma_f32_32x32x16_bf16 v[80:95], v[152:155], v[192:195], v[80:95]
    ds_read_b64_tr_b16 v[144:145], v28 offset:40960
    ds_read_b64_tr_b16 v[146:147], v28 offset:41472
    s_add_u32 s88, s62, 4
    s_cmp_ge_u32 s88, 9
    s_cselect_b32 s7, 9, 0
    s_sub_u32 s88, s88, s7
    s_mul_i32 s88, s88, 4096
    s_mov_b64 exec, s[50:51]
    buffer_store_dwordx4 v[48:51], v31, s[28:31], s88 offen offset:0 sc1
    s_mov_b64 exec, -1
    s_waitcnt lgkmcnt(10)
    v_mfma_f32_32x32x16_bf16 v[80:95], v[156:159], v[196:199], v[80:95]
    ds_read_b64_tr_b16 v[148:149], v28 offset:43008
    ds_read_b64_tr_b16 v[150:151], v28 offset:43520
    s_mov_b64 exec, s[50:51]
    buffer_store_dwordx4 v[52:55], v31, s[28:31], s88 offen offset:1024 sc1
    s_mov_b64 exec, -1
    s_mov_b64 exec, s[52:53]
    s_cbranch_execz L_kp4
    ds_write_b128 v4, v[48:51] offset:2048
    ds_write_b128 v4, v[52:55] offset:2304
L_kp4:
    s_mov_b64 exec, -1
    s_waitcnt lgkmcnt(10)
    v_mfma_f32_32x32x16_bf16 v[80:95], v[128:131], v[216:219], v[80:95]
    ds_read_b64_tr_b16 v[152:153], v28 offset:45056
    ds_read_b64_tr_b16 v[154:155], v28 offset:45568
    s_waitcnt lgkmcnt(10)
    v_mfma_f32_32x32x16_bf16 v[80:95], v[132:135], v[220:223], v[80:95]
    ds_read_b64_tr_b16 v[156:157], v28 offset:47104
    ds_read_b64_tr_b16 v[158:159], v28 offset:47616
    s_waitcnt lgkmcnt(10)
    v_mfma_f32_32x32x16_bf16 v[80:95], v[136:139], v[224:227], v[80:95]
    s_waitcnt lgkmcnt(8)
    v_mfma_f32_32x32x16_bf16 v[80:95], v[140:143], v[228:231], v[80:95]
    s_waitcnt lgkmcnt(6)
    v_mfma_f32_32x32x16_bf16 v[80:95], v[144:147], v[232:235], v[80:95]
    s_waitcnt lgkmcnt(0)
    s_barrier
    ds_read_b64_tr_b16 v[128:129], v29 offset:0
    ds_read_b64_tr_b16 v[130:131], v29 offset:512
    ds_read_b64_tr_b16 v[132:133], v29 offset:2048
    v_mfma_f32_32x32x16_bf16 v[80:95], v[148:151], v[236:239], v[80:95]
    ds_read_b64_tr_b16 v[134:135], v29 offset:2560
    ds_read_b64_tr_b16 v[136:137], v29 offset:4096
    ds_read_b64_tr_b16 v[138:139], v29 offset:4608
    v_mfma_f32_32x32x16_bf16 v[80:95], v[152:155], v[240:243], v[80:95]
    ds_read_b64_tr_b16 v[140:141], v29 offset:6144
    ds_read_b64_tr_b16 v[142:143], v29 offset:6656
    ds_read_b64_tr_b16 v[144:145], v29 offset:8192
    v_mfma_f32_32x32x16_bf16 v[80:95], v[156:159], v[244:247], v[80:95]
    ds_read_b64_tr_b16 v[146:147], v29 offset:8704
    ds_read_b64_tr_b16 v[148:149], v29 offset:10240
    ds_read_b64_tr_b16 v[150:151], v29 offset:10752
    s_waitcnt lgkmcnt(10)
    v_mfma_f32_32x32x16_bf16 v[64:79], v[128:131], v[168:171], 0
    ds_read_b64_tr_b16 v[152:153], v29 offset:12288
    ds_read_b64_tr_b16 v[154:155], v29 offset:12800
    s_waitcnt lgkmcnt(10)
    v_mfma_f32_32x32x16_bf16 v[64:79], v[132:135], v[172:175], v[64:79]
    ds_read_b64_tr_b16 v[156:157], v29 offset:14336
    ds_read_b64_tr_b16 v[158:159], v29 offset:14848
    s_waitcnt lgkmcnt(10)
    v_mfma_f32_32x32x16_bf16 v[64:79], v[136:139], v[176:179], v[64:79]
    ds_read_b64_tr_b16 v[128:129], v30 offset:0
    ds_read_b64_tr_b16 v[130:131], v30 offset:512
    v_cvt_pk_bf16_f32 v56, v80, v81
    v_cvt_pk_bf16_f32 v57, v82, v83
    s_waitcnt lgkmcnt(10)
    v_mfma_f32_32x32x16_bf16 v[64:79], v[140:143], v[180:183], v[64:79]
    ds_read_b64_tr_b16 v[132:133], v30 offset:2048
    ds_read_b64_tr_b16 v[134:135], v30 offset:2560
    v_cvt_pk_bf16_f32 v58, v84, v85
    v_cvt_pk_bf16_f32 v59, v86, v87
    s_waitcnt lgkmcnt(10)
    v_mfma_f32_32x32x16_bf16 v[64:79], v[144:147], v[184:187], v[64:79]
    ds_read_b64_tr_b16 v[136:137], v30 offset:4096
    ds_read_b64_tr_b16 v[138:139], v30 offset:4608
    v_cvt_pk_bf16_f32 v60, v88, v89
    v_cvt_pk_bf16_f32 v61, v90, v91
    s_waitcnt lgkmcnt(10)
    v_mfma_f32_32x32x16_bf16 v[64:79], v[148:151], v[188:191], v[64:79]
    ds_read_b64_tr_b16 v[140:141], v30 offset:6144
    ds_read_b64_tr_b16 v[142:143], v30 offset:6656
    v_cvt_pk_bf16_f32 v62, v92, v93
    v_cvt_pk_bf16_f32 v63, v94, v95
    s_waitcnt lgkmcnt(10)
    v_mfma_f32_32x32x16_bf16 v[64:79], v[152:155], v[192:195], v[64:79]
    ds_read_b64_tr_b16 v[144:145], v30 offset:8192
    ds_read_b64_tr_b16 v[146:147], v30 offset:8704
    s_add_u32 s88, s62, 5
    s_cmp_ge_u32 s88, 9
    s_cselect_b32 s7, 9, 0
    s_sub_u32 s88, s88, s7
    s_mul_i32 s88, s88, 4096
    s_mov_b64 exec, s[50:51]
    buffer_store_dwordx4 v[56:59], v31, s[28:31], s88 offen offset:0 sc1
    s_mov_b64 exec, -1
    s_waitcnt lgkmcnt(10)
    v_mfma_f32_32x32x16_bf16 v[64:79], v[156:159], v[196:199], v[64:79]
    ds_read_b64_tr_b16 v[148:149], v30 offset:10240
    ds_read_b64_tr_b16 v[150:151], v30 offset:10752
    s_mov_b64 exec, s[50:51]
    buffer_store_dwordx4 v[60:63], v31, s[28:31], s88 offen offset:1024 sc1
    s_mov_b64 exec, -1
    s_mov_b64 exec, s[52:53]
    s_cbranch_execz L_kp5
    ds_write_b128 v4, v[56:59] offset:2560
    ds_write_b128 v4, v[60:63] offset:2816
L_kp5:
    s_mov_b64 exec, -1
    s_waitcnt lgkmcnt(10)
    v_mfma_f32_32x32x16_bf16 v[64:79], v[128:131], v[216:219], v[64:79]
    ds_read_b64_tr_b16 v[152:153], v30 offset:12288
    ds_read_b64_tr_b16 v[154:155], v30 offset:12800
    s_waitcnt lgkmcnt(10)
    v_mfma_f32_32x32x16_bf16 v[64:79], v[132:135], v[220:223], v[64:79]
    ds_read_b64_tr_b16 v[156:157], v30 offset:14336
    ds_read_b64_tr_b16 v[158:159], v30 offset:14848
    s_waitcnt lgkmcnt(10)
    v_mfma_f32_32x32x16_bf16 v[64:79], v[136:139], v[224:227], v[64:79]
    s_waitcnt lgkmcnt(8)
    v_mfma_f32_32x32x16_bf16 v[64:79], v[140:143], v[228:231], v[64:79]
    s_waitcnt vmcnt(2)
    s_waitcnt lgkmcnt(6)
    v_mfma_f32_32x32x16_bf16 v[64:79], v[144:147], v[232:235], v[64:79]
    s_waitcnt lgkmcnt(0)
    s_barrier
    ds_read_b64_tr_b16 v[128:129], v29 offset:32768
    ds_read_b64_tr_b16 v[130:131], v29 offset:33280
    ds_read_b64_tr_b16 v[132:133], v29 offset:34816
    v_mfma_f32_32x32x16_bf16 v[64:79], v[148:151], v[236:239], v[64:79]
    ds_read_b64_tr_b16 v[134:135], v29 offset:35328
    ds_read_b64_tr_b16 v[136:137], v29 offset:36864
    ds_read_b64_tr_b16 v[138:139], v29 offset:37376
    v_mfma_f32_32x32x16_bf16 v[64:79], v[152:155], v[240:243], v[64:79]
    ds_read_b64_tr_b16 v[140:141], v29 offset:38912
    ds_read_b64_tr_b16 v[142:143], v29 offset:39424
    ds_read_b64_tr_b16 v[144:145], v29 offset:40960
    v_mfma_f32_32x32x16_bf16 v[64:79], v[156:159], v[244:247], v[64:79]
    ds_read_b64_tr_b16 v[146:147], v29 offset:41472
    ds_read_b64_tr_b16 v[148:149], v29 offset:43008
    ds_read_b64_tr_b16 v[150:151], v29 offset:43520
    s_waitcnt lgkmcnt(10)
    v_mfma_f32_32x32x16_bf16 v[80:95], v[128:131], v[168:171], 0
    ds_read_b64_tr_b16 v[152:153], v29 offset:45056
    ds_read_b64_tr_b16 v[154:155], v29 offset:45568
    s_waitcnt lgkmcnt(10)
    v_mfma_f32_32x32x16_bf16 v[80:95], v[132:135], v[172:175], v[80:95]
    ds_read_b64_tr_b16 v[156:157], v29 offset:47104
    ds_read_b64_tr_b16 v[158:159], v29 offset:47616
    s_waitcnt lgkmcnt(10)
    v_mfma_f32_32x32x16_bf16 v[80:95], v[136:139], v[176:179], v[80:95]
    ds_read_b64_tr_b16 v[128:129], v30 offset:32768
    ds_read_b64_tr_b16 v[130:131], v30 offset:33280
    v_cvt_pk_bf16_f32 v96, v64, v65
    v_cvt_pk_bf16_f32 v97, v66, v67
    s_waitcnt lgkmcnt(10)
    v_mfma_f32_32x32x16_bf16 v[80:95], v[140:143], v[180:183], v[80:95]
    ds_read_b64_tr_b16 v[132:133], v30 offset:34816
    ds_read_b64_tr_b16 v[134:135], v30 offset:35328
    v_cvt_pk_bf16_f32 v98, v68, v69
    v_cvt_pk_bf16_f32 v99, v70, v71
    s_waitcnt lgkmcnt(10)
    v_mfma_f32_32x32x16_bf16 v[80:95], v[144:147], v[184:187], v[80:95]
    ds_read_b64_tr_b16 v[136:137], v30 offset:36864
    ds_read_b64_tr_b16 v[138:139], v30 offset:37376
    v_cvt_pk_bf16_f32 v100, v72, v73
    v_cvt_pk_bf16_f32 v101, v74, v75
    s_waitcnt lgkmcnt(10)
    v_mfma_f32_32x32x16_bf16 v[80:95], v[148:151], v[188:191], v[80:95]
    ds_read_b64_tr_b16 v[140:141], v30 offset:38912
    ds_read_b64_tr_b16 v[142:143], v30 offset:39424
    v_cvt_pk_bf16_f32 v102, v76, v77
    v_cvt_pk_bf16_f32 v103, v78, v79
    s_waitcnt lgkmcnt(10)
    v_mfma_f32_32x32x16_bf16 v[80:95], v[152:155], v[192:195], v[80:95]
    ds_read_b64_tr_b16 v[144:145], v30 offset:40960
    ds_read_b64_tr_b16 v[146:147], v30 offset:41472
    s_add_u32 s88, s62, 6
    s_cmp_ge_u32 s88, 9
    s_cselect_b32 s7, 9, 0
    s_sub_u32 s88, s88, s7
    s_mul_i32 s88, s88, 4096
    s_mov_b64 exec, s[50:51]
    buffer_store_dwordx4 v[96:99], v31, s[28:31], s88 offen offset:0 sc1
    s_mov_b64 exec, -1
    s_waitcnt lgkmcnt(10)
    v_mfma_f32_32x32x16_bf16 v[80:95], v[156:159], v[196:199], v[80:95]
    ds_read_b64_tr_b16 v[148:149], v30 offset:43008
    ds_read_b64_tr_b16 v[150:151], v30 offset:43520
    s_mov_b64 exec, s[50:51]
    buffer_store_dwordx4 v[100:103], v31, s[28:31], s88 offen offset:1024 sc1
    s_mov_b64 exec, -1
    s_mov_b64 exec, s[52:53]
    s_cbranch_execz L_kp6
    ds_write_b128 v4, v[96:99] offset:3072
    ds_write_b128 v4, v[100:103] offset:3328
L_kp6:
    s_mov_b64 exec, -1
    s_waitcnt lgkmcnt(10)
    v_mfma_f32_32x32x16_bf16 v[80:95], v[128:131], v[216:219], v[80:95]
    ds_read_b64_tr_b16 v[152:153], v30 offset:45056
    ds_read_b64_tr_b16 v[154:155], v30 offset:45568
    s_waitcnt lgkmcnt(10)
    v_mfma_f32_32x32x16_bf16 v[80:95], v[132:135], v[220:223], v[80:95]
    ds_read_b64_tr_b16 v[156:157], v30 offset:47104
    ds_read_b64_tr_b16 v[158:159], v30 offset:47616
    s_waitcnt lgkmcnt(10)
    v_mfma_f32_32x32x16_bf16 v[80:95], v[136:139], v[224:227], v[80:95]
    s_waitcnt lgkmcnt(8)
    v_mfma_f32_32x32x16_bf16 v[80:95], v[140:143], v[228:231], v[80:95]
    s_waitcnt lgkmcnt(6)
    v_mfma_f32_32x32x16_bf16 v[80:95], v[144:147], v[232:235], v[80:95]
    s_waitcnt lgkmcnt(0)
    s_barrier
    ds_read_b64_tr_b16 v[128:129], v27 offset:0
    ds_read_b64_tr_b16 v[130:131], v27 offset:512
    ds_read_b64_tr_b16 v[132:133], v27 offset:2048
    v_mfma_f32_32x32x16_bf16 v[80:95], v[148:151], v[236:239], v[80:95]
    ds_read_b64_tr_b16 v[134:135], v27 offset:2560
    ds_read_b64_tr_b16 v[136:137], v27 offset:4096
    ds_read_b64_tr_b16 v[138:139], v27 offset:4608
    v_mfma_f32_32x32x16_bf16 v[80:95], v[152:155], v[240:243], v[80:95]
    ds_read_b64_tr_b16 v[140:141], v27 offset:6144
    ds_read_b64_tr_b16 v[142:143], v27 offset:6656
    ds_read_b64_tr_b16 v[144:145], v27 offset:8192
    v_mfma_f32_32x32x16_bf16 v[80:95], v[156:159], v[244:247], v[80:95]
    ds_read_b64_tr_b16 v[146:147], v27 offset:8704
    ds_read_b64_tr_b16 v[148:149], v27 offset:10240
    ds_read_b64_tr_b16 v[150:151], v27 offset:10752
    s_waitcnt lgkmcnt(10)
    v_mfma_f32_32x32x16_bf16 v[64:79], v[128:131], v[168:171], 0
    ds_read_b64_tr_b16 v[152:153], v27 offset:12288
    ds_read_b64_tr_b16 v[154:155], v27 offset:12800
    s_waitcnt lgkmcnt(10)
    v_mfma_f32_32x32x16_bf16 v[64:79], v[132:135], v[172:175], v[64:79]
    ds_read_b64_tr_b16 v[156:157], v27 offset:14336
    ds_read_b64_tr_b16 v[158:159], v27 offset:14848
    s_waitcnt lgkmcnt(10)
    v_mfma_f32_32x32x16_bf16 v[64:79], v[136:139], v[176:179], v[64:79]
    ds_read_b64_tr_b16 v[128:129], v28 offset:0
    ds_read_b64_tr_b16 v[130:131], v28 offset:512
    v_cvt_pk_bf16_f32 v104, v80, v81
    v_cvt_pk_bf16_f32 v105, v82, v83
    s_waitcnt lgkmcnt(10)
    v_mfma_f32_32x32x16_bf16 v[64:79], v[140:143], v[180:183], v[64:79]
    ds_read_b64_tr_b16 v[132:133], v28 offset:2048
    ds_read_b64_tr_b16 v[134:135], v28 offset:2560
    v_cvt_pk_bf16_f32 v106, v84, v85
    v_cvt_pk_bf16_f32 v107, v86, v87
    s_waitcnt lgkmcnt(10)
    v_mfma_f32_32x32x16_bf16 v[64:79], v[144:147], v[184:187], v[64:79]
    ds_read_b64_tr_b16 v[136:137], v28 offset:4096
    ds_read_b64_tr_b16 v[138:139], v28 offset:4608
    v_cvt_pk_bf16_f32 v108, v88, v89
    v_cvt_pk_bf16_f32 v109, v90, v91
    s_waitcnt lgkmcnt(10)
    v_mfma_f32_32x32x16_bf16 v[64:79], v[148:151], v[188:191], v[64:79]
    ds_read_b64_tr_b16 v[140:141], v28 offset:6144
    ds_read_b64_tr_b16 v[142:143], v28 offset:6656
    v_cvt_pk_bf16_f32 v110, v92, v93
    v_cvt_pk_bf16_f32 v111, v94, v95
    s_waitcnt lgkmcnt(10)
    v_mfma_f32_32x32x16_bf16 v[64:79], v[152:155], v[192:195], v[64:79]
    ds_read_b64_tr_b16 v[144:145], v28 offset:8192
    ds_read_b64_tr_b16 v[146:147], v28 offset:8704
    s_add_u32 s88, s62, 7
    s_cmp_ge_u32 s88, 9
    s_cselect_b32 s7, 9, 0
    s_sub_u32 s88, s88, s7
    s_mul_i32 s88, s88, 4096
    s_mov_b64 exec, s[50:51]
    buffer_store_dwordx4 v[104:107], v31, s[28:31], s88 offen offset:0 sc1
    s_mov_b64 exec, -1
    s_waitcnt lgkmcnt(10)
    v_mfma_f32_32x32x16_bf16 v[64:79], v[156:159], v[196:199], v[64:79]
    ds_read_b64_tr_b16 v[148:149], v28 offset:10240
    ds_read_b64_tr_b16 v[150:151], v28 offset:10752
    s_mov_b64 exec, s[50:51]
    buffer_store_dwordx4 v[108:111], v31, s[28:31], s88 offen offset:1024 sc1
    s_mov_b64 exec, -1
    s_mov_b64 exec, s[52:53]
    s_cbranch_execz L_kp7
    ds_write_b128 v4, v[104:107] offset:3584
    ds_write_b128 v4, v[108:111] offset:3840
L_kp7:
    s_mov_b64 exec, -1
    s_waitcnt lgkmcnt(10)
    v_mfma_f32_32x32x16_bf16 v[64:79], v[128:131], v[216:219], v[64:79]
    ds_read_b64_tr_b16 v[152:153], v28 offset:12288
    ds_read_b64_tr_b16 v[154:155], v28 offset:12800
    s_waitcnt lgkmcnt(10)
    v_mfma_f32_32x32x16_bf16 v[64:79], v[132:135], v[220:223], v[64:79]
    ds_read_b64_tr_b16 v[156:157], v28 offset:14336
    ds_read_b64_tr_b16 v[158:159], v28 offset:14848
    s_waitcnt lgkmcnt(10)
    v_mfma_f32_32x32x16_bf16 v[64:79], v[136:139], v[224:227], v[64:79]
    s_waitcnt lgkmcnt(8)
    v_mfma_f32_32x32x16_bf16 v[64:79], v[140:143], v[228:231], v[64:79]
    s_waitcnt lgkmcnt(6)
    v_mfma_f32_32x32x16_bf16 v[64:79], v[144:147], v[232:235], v[64:79]
    s_waitcnt lgkmcnt(4)
    v_mfma_f32_32x32x16_bf16 v[64:79], v[148:151], v[236:239], v[64:79]
    s_waitcnt lgkmcnt(2)
    v_mfma_f32_32x32x16_bf16 v[64:79], v[152:155], v[240:243], v[64:79]
    s_waitcnt lgkmcnt(0)
    v_mfma_f32_32x32x16_bf16 v[64:79], v[156:159], v[244:247], v[64:79]
    s_nop 11
    v_cvt_pk_bf16_f32 v112, v64, v65
    v_cvt_pk_bf16_f32 v113, v66, v67
    v_cvt_pk_bf16_f32 v114, v68, v69
    v_cvt_pk_bf16_f32 v115, v70, v71
    v_cvt_pk_bf16_f32 v116, v72, v73
    v_cvt_pk_bf16_f32 v117, v74, v75
    v_cvt_pk_bf16_f32 v118, v76, v77
    v_cvt_pk_bf16_f32 v119, v78, v79
    s_add_u32 s88, s62, 8
    s_cmp_ge_u32 s88, 9
    s_cselect_b32 s7, 9, 0
    s_sub_u32 s88, s88, s7
    s_mul_i32 s88, s88, 4096
    s_mov_b64 exec, s[50:51]
    buffer_store_dwordx4 v[112:115], v31, s[28:31], s88 offen offset:0 sc1
    s_mov_b64 exec, -1
    s_mov_b64 exec, s[50:51]
    buffer_store_dwordx4 v[116:119], v31, s[28:31], s88 offen offset:1024 sc1
    s_mov_b64 exec, -1
    s_mov_b64 exec, s[52:53]
    s_cbranch_execz L_kp8
    ds_write_b128 v4, v[112:115] offset:4096
    ds_write_b128 v4, v[116:119] offset:4352
L_kp8:
    s_mov_b64 exec, -1
    s_waitcnt vmcnt(0)
    s_mov_b64 exec, 1
    ds_add_rtn_u32 v3, v5, v47
    s_waitcnt lgkmcnt(0)
    v_readfirstlane_b32 s7, v3
    s_mov_b64 exec, 0xffff
    s_cmp_lg_u32 s7, 3
    s_cbranch_scc1 L_nosig
    buffer_store_dword v47, v39, s[20:23], 0 offen sc1
L_nosig:
    s_mov_b64 exec, -1
    s_lshl_b32 s88, s4, 3
    s_add_u32 s88, s88, s6
    s_mul_i32 s88, s88, 1179648
    s_add_u32 s24, s60, s88
    s_addc_u32 s25, s61, 0
    s_mov_b32 s26, 0x120000
    s_mov_b32 s27, 0x00020000
    s_mov_b32 s8, s56
    s_mov_b32 s9, s57
    s_mov_b32 s10, 0x120000
    s_mov_b32 s11, 0x00020000
    v_mov_b32 v4, 155648
    s_bfe_u32 s88, s5, 0x10002
    s_mul_i32 s89, s88, 36864
    s_and_b32 s90, s5, 3
    s_lshl_b32 s7, s90, 7
    s_add_u32 s89, s89, s7
    s_lshr_b32 s90, s5, 3
    s_lshl_b32 s7, s90, 11
    s_add_u32 s89, s89, s7
    v_lshrrev_b32 v5, 5, v0
    v_mul_u32_u24 v7, 73728, v5
    v_bfe_u32 v6, v0, 3, 2
    v_lshl_add_u32 v7, v6, 9, v7
    v_and_b32 v6, 7, v0
    v_lshl_add_u32 v7, v6, 4, v7
    v_add_u32 v2, s89, v7
    s_and_b32 s88, s5, 7
    s_lshl_b32 s7, s6, 3
    s_add_u32 s88, s88, s7
    s_mul_i32 s88, s88, 18432
    s_mul_i32 s7, s4, 1152
    s_add_u32 s88, s88, s7
    s_lshl_b32 s7, s90, 6
    s_add_u32 s88, s88, s7
    v_mul_u32_u24 v7, 2304, v6
    v_lshl_add_u32 v7, v5, 5, v7
    v_bfe_u32 v6, v0, 3, 1
    v_lshl_add_u32 v7, v6, 4, v7
    v_bfe_u32 v6, v0, 4, 1
    v_lshl_add_u32 v7, v6, 3, v7
    v_add_u32 v3, s88, v7
    v_lshlrev_b32 v6, 2, v6
    v_bfe_u32 v5, v0, 1, 3
    v_sub_u32 v5, v5, v6
    v_and_b32 v7, 1, v0
    v_lshlrev_b32 v7, 4, v7
    v_mov_b32 v6, 0x3f80
    v_lshlrev_b32 v6, v7, v6
    v_cmp_eq_u32 vcc, 0, v5
    s_nop 1
    v_cndmask_b32 v8, 0, v6, vcc
    v_cmp_eq_u32 vcc, 1, v5
    s_nop 1
    v_cndmask_b32 v9, 0, v6, vcc
    v_cmp_eq_u32 vcc, 2, v5
    s_nop 1
    v_cndmask_b32 v10, 0, v6, vcc
    v_cmp_eq_u32 vcc, 3, v5
    s_nop 1
    v_cndmask_b32 v11, 0, v6, vcc
    s_add_u32 s46, s95, 5
    s_mov_b32 s47, 2
    s_mov_b32 s48, 9
L_tail:
    s_cmp_ge_u32 s46, s48
    s_cbranch_scc1 L_done
    s_lshl_b32 s7, s46, 9
    s_add_u32 s7, s7, 147456
    v_and_b32 v5, 31, v0
    v_lshl_add_u32 v16, v5, 4, s7
    s_and_b32 s7, s5, 1
    s_cselect_b32 s52, 0, -1
    s_cselect_b32 s53, -1, 0
    s_cselect_b32 s54, -1, 0
    s_cselect_b32 s55, 0, -1
    s_lshr_b32 s7, s5, 1
    s_mul_i32 s56, s7, 147456
    s_add_u32 s89, s46, s6
    s_cmp_ge_u32 s89, 9
    s_cselect_b32 s7, 9, 0
    s_sub_u32 s89, s89, s7
    s_lshl_b32 s88, s89, 12
    s_lshl_b32 s89, s89, 7
    s_add_u32 s51, s46, s6
    s_add_u32 s51, s51, 3
    s_cmp_ge_u32 s51, 9
    s_cselect_b32 s7, 9, 0
    s_sub_u32 s51, s51, s7
    s_lshl_b32 s50, s51, 12
    s_lshl_b32 s51, s51, 7
    s_add_u32 s46, s46, 3
    s_cmp_eq_u32 s47, 2
    s_cselect_b32 s46, 9, s46
    s_mov_b32 s7, 0
L_lw:
    ds_read_b32 v6, v4
    s_add_u32 s7, s7, 1
    s_cmp_gt_u32 s7, 1200000
    s_waitcnt lgkmcnt(0)
    s_cbranch_scc1 L_lw_x
    v_cmp_gt_u32 vcc, s47, v6
    s_cbranch_vccz L_lw_x
    s_branch L_lw
L_lw_x:
    s_mov_b32 s57, s56
    s_mov_b64 exec, s[54:55]
    s_add_u32 s90, s57, s88
    buffer_load_dwordx4 v[128:131], v2, s[24:27], s90 offen sc1
    s_mov_b64 exec, s[52:53]
    ds_read_b128 v[128:131], v16 offset:0
    s_mov_b64 exec, -1
    s_add_u32 s57, s57, 147456
    s_cmp_ge_u32 s57, 1179648
    s_cselect_b32 s7, 1179648, 0
    s_sub_u32 s57, s57, s7
    s_add_u32 s90, s57, s88
    buffer_load_dwordx4 v[132:135], v2, s[24:27], s90 offen sc1
    s_add_u32 s57, s57, 147456
    s_cmp_ge_u32 s57, 1179648
    s_cselect_b32 s7, 1179648, 0
    s_sub_u32 s57, s57, s7
    s_add_u32 s90, s57, s88
    buffer_load_dwordx4 v[136:139], v2, s[24:27], s90 offen sc1
    s_add_u32 s57, s57, 147456
    s_cmp_ge_u32 s57, 1179648
    s_cselect_b32 s7, 1179648, 0
    s_sub_u32 s57, s57, s7
    s_add_u32 s90, s57, s88
    buffer_load_dwordx4 v[140:143], v2, s[24:27], s90 offen sc1
    s_add_u32 s57, s57, 147456
    s_cmp_ge_u32 s57, 1179648
    s_cselect_b32 s7, 1179648, 0
    s_sub_u32 s57, s57, s7
    s_add_u32 s90, s57, s88
    buffer_load_dwordx4 v[144:147], v2, s[24:27], s90 offen sc1
    s_add_u32 s57, s57, 147456
    s_cmp_ge_u32 s57, 1179648
    s_cselect_b32 s7, 1179648, 0
    s_sub_u32 s57, s57, s7
    s_add_u32 s90, s57, s88
    buffer_load_dwordx4 v[148:151], v2, s[24:27], s90 offen sc1
    s_add_u32 s57, s57, 147456
    s_cmp_ge_u32 s57, 1179648
    s_cselect_b32 s7, 1179648, 0
    s_sub_u32 s57, s57, s7
    s_add_u32 s90, s57, s88
    buffer_load_dwordx4 v[152:155], v2, s[24:27], s90 offen sc1
    s_add_u32 s57, s57, 147456
    s_cmp_ge_u32 s57, 1179648
    s_cselect_b32 s7, 1179648, 0
    s_sub_u32 s57, s57, s7
    s_add_u32 s90, s57, s88
    buffer_load_dwordx4 v[156:159], v2, s[24:27], s90 offen sc1
    s_cmp_lt_u32 s46, s48
    s_cbranch_scc1 L_two
    s_waitcnt vmcnt(7) lgkmcnt(0)
    v_mfma_f32_16x16x32_bf16 v[192:195], v[8:11], v[128:131], 0
    s_waitcnt vmcnt(6)
    v_mfma_f32_16x16x32_bf16 v[192:195], v[8:11], v[132:135], v[192:195]
    s_waitcnt vmcnt(5)
    v_mfma_f32_16x16x32_bf16 v[192:195], v[8:11], v[136:139], v[192:195]
    s_waitcnt vmcnt(4)
    v_mfma_f32_16x16x32_bf16 v[192:195], v[8:11], v[140:143], v[192:195]
    s_waitcnt vmcnt(3)
    v_mfma_f32_16x16x32_bf16 v[192:195], v[8:11], v[144:147], v[192:195]
    s_waitcnt vmcnt(2)
    v_mfma_f32_16x16x32_bf16 v[192:195], v[8:11], v[148:151], v[192:195]
    s_waitcnt vmcnt(1)
    v_mfma_f32_16x16x32_bf16 v[192:195], v[8:11], v[152:155], v[192:195]
    s_waitcnt vmcnt(0)
    v_mfma_f32_16x16x32_bf16 v[192:195], v[8:11], v[156:159], v[192:195]
    s_nop 7
    v_cvt_pk_bf16_f32 v12, v192, v193
    v_cvt_pk_bf16_f32 v13, v194, v195
    buffer_store_dwordx2 v[12:13], v3, s[8:11], s89 offen nt
    s_branch L_fin
L_two:
    s_mov_b32 s57, s56
    s_mov_b64 exec, s[54:55]
    s_add_u32 s90, s57, s50
    buffer_load_dwordx4 v[160:163], v2, s[24:27], s90 offen sc1
    s_mov_b64 exec, s[52:53]
    ds_read_b128 v[160:163], v16 offset:1536
    s_mov_b64 exec, -1
    s_add_u32 s57, s57, 147456
    s_cmp_ge_u32 s57, 1179648
    s_cselect_b32 s7, 1179648, 0
    s_sub_u32 s57, s57, s7
    s_add_u32 s90, s57, s50
    buffer_load_dwordx4 v[164:167], v2, s[24:27], s90 offen sc1
    s_add_u32 s57, s57, 147456
    s_cmp_ge_u32 s57, 1179648
    s_cselect_b32 s7, 1179648, 0
    s_sub_u32 s57, s57, s7
    s_add_u32 s90, s57, s50
    buffer_load_dwordx4 v[168:171], v2, s[24:27], s90 offen sc1
    s_add_u32 s57, s57, 147456
    s_cmp_ge_u32 s57, 1179648
    s_cselect_b32 s7, 1179648, 0
    s_sub_u32 s57, s57, s7
    s_add_u32 s90, s57, s50
    buffer_load_dwordx4 v[172:175], v2, s[24:27], s90 offen sc1
    s_add_u32 s57, s57, 147456
    s_cmp_ge_u32 s57, 1179648
    s_cselect_b32 s7, 1179648, 0
    s_sub_u32 s57, s57, s7
    s_add_u32 s90, s57, s50
    buffer_load_dwordx4 v[176:179], v2, s[24:27], s90 offen sc1
    s_add_u32 s57, s57, 147456
    s_cmp_ge_u32 s57, 1179648
    s_cselect_b32 s7, 1179648, 0
    s_sub_u32 s57, s57, s7
    s_add_u32 s90, s57, s50
    buffer_load_dwordx4 v[180:183], v2, s[24:27], s90 offen sc1
    s_add_u32 s57, s57, 147456
    s_cmp_ge_u32 s57, 1179648
    s_cselect_b32 s7, 1179648, 0
    s_sub_u32 s57, s57, s7
    s_add_u32 s90, s57, s50
    buffer_load_dwordx4 v[184:187], v2, s[24:27], s90 offen sc1
    s_add_u32 s57, s57, 147456
    s_cmp_ge_u32 s57, 1179648
    s_cselect_b32 s7, 1179648, 0
    s_sub_u32 s57, s57, s7
    s_add_u32 s90, s57, s50
    buffer_load_dwordx4 v[188:191], v2, s[24:27], s90 offen sc1
    s_waitcnt vmcnt(15) lgkmcnt(0)
    v_mfma_f32_16x16x32_bf16 v[192:195], v[8:11], v[128:131], 0
    s_waitcnt vmcnt(14)
    v_mfma_f32_16x16x32_bf16 v[192:195], v[8:11], v[132:135], v[192:195]
    s_waitcnt vmcnt(13)
    v_mfma_f32_16x16x32_bf16 v[192:195], v[8:11], v[136:139], v[192:195]
    s_waitcnt vmcnt(12)
    v_mfma_f32_16x16x32_bf16 v[192:195], v[8:11], v[140:143], v[192:195]
    s_waitcnt vmcnt(11)
    v_mfma_f32_16x16x32_bf16 v[192:195], v[8:11], v[144:147], v[192:195]
    s_waitcnt vmcnt(10)
    v_mfma_f32_16x16x32_bf16 v[192:195], v[8:11], v[148:151], v[192:195]
    s_waitcnt vmcnt(9)
    v_mfma_f32_16x16x32_bf16 v[192:195], v[8:11], v[152:155], v[192:195]
    s_waitcnt vmcnt(8)
    v_mfma_f32_16x16x32_bf16 v[192:195], v[8:11], v[156:159], v[192:195]
    s_waitcnt vmcnt(7) lgkmcnt(0)
    v_mfma_f32_16x16x32_bf16 v[196:199], v[8:11], v[160:163], 0
    s_waitcnt vmcnt(6)
    v_mfma_f32_16x16x32_bf16 v[196:199], v[8:11], v[164:167], v[196:199]
    s_waitcnt vmcnt(5)
    v_mfma_f32_16x16x32_bf16 v[196:199], v[8:11], v[168:171], v[196:199]
    s_waitcnt vmcnt(4)
    v_mfma_f32_16x16x32_bf16 v[196:199], v[8:11], v[172:175], v[196:199]
    s_waitcnt vmcnt(3)
    v_mfma_f32_16x16x32_bf16 v[196:199], v[8:11], v[176:179], v[196:199]
    s_waitcnt vmcnt(2)
    v_mfma_f32_16x16x32_bf16 v[196:199], v[8:11], v[180:183], v[196:199]
    s_waitcnt vmcnt(1)
    v_mfma_f32_16x16x32_bf16 v[196:199], v[8:11], v[184:187], v[196:199]
    s_waitcnt vmcnt(0)
    v_mfma_f32_16x16x32_bf16 v[196:199], v[8:11], v[188:191], v[196:199]
    v_cvt_pk_bf16_f32 v12, v192, v193
    v_cvt_pk_bf16_f32 v13, v194, v195
    buffer_store_dwordx2 v[12:13], v3, s[8:11], s89 offen nt
    s_nop 4
    v_cvt_pk_bf16_f32 v14, v196, v197
    v_cvt_pk_bf16_f32 v15, v198, v199
    buffer_store_dwordx2 v[14:15], v3, s[8:11], s51 offen nt
L_fin:
L_done:
L_main_end:
    s_endpgm
L_code_end:
.section .rodata,"a"
.p2align 6
.amdhsa_kernel concat_heads__gqa_block_cached__gqa_block_cached__near_ridge_kernel
  .amdhsa_next_free_vgpr 256
  .amdhsa_next_free_sgpr 102
  .amdhsa_accum_offset 256
  .amdhsa_group_segment_fixed_size 0
  .amdhsa_kernarg_size 104
  .amdhsa_user_sgpr_count 2
  .amdhsa_user_sgpr_kernarg_segment_ptr 1
  .amdhsa_system_sgpr_workgroup_id_x 1
  .amdhsa_float_denorm_mode_32 3
.end_amdhsa_kernel
```
